```python
import torch

def _softmax(x, axis=-1):
    return torch.softmax(x, dim=axis)

def _gelu(x):
    return torch.nn.functional.gelu(x, approximate='tanh')

def _silu(x):
    return torch.nn.functional.silu(x)

def _sigmoid(x):
    return torch.sigmoid(x)

def _layernorm(x, axis=-1, eps=1e-05):
    m = x.mean(dim=axis, keepdim=True)
    v = x.var(dim=axis, keepdim=True, unbiased=False)
    return (x - m) / torch.sqrt(v + eps)

def _scatter_add(tgt, idx, src, axis=0):
    return tgt.clone().index_add_(axis, idx, src)

def _segment_sum(src, seg, n):
    out = torch.zeros((n,) + src.shape[1:], dtype=src.dtype)
    return out.index_add_(0, seg, src)

def _pad(x, pw):
    flat = tuple((v for pair in reversed(pw) for v in pair))
    return torch.nn.functional.pad(x, flat)
kernel_name = 'adaLN_cond__gqa_block_cached__glu_gated_swiglu__decode'

def setup_inputs():

    _w = lambda a: (lambda t: t.to(torch.bfloat16) if t.is_floating_point() else t)(torch.as_tensor(a))

    def _A_setup():
        B, Sq, D = (2, 1, 576)
        Hq, Hkv, Sk, Dh = (32, 16, 8192, 128)
        assert Hq % Hkv == 0, (Hq, Hkv)
        return {'x': _w((lambda *s: torch.randn(*s, dtype=torch.bfloat16) * 0.1)(B, Sq, D)), 'k_cache': _w((lambda *s: torch.randn(*s, dtype=torch.bfloat16) * 0.8)(B, Hkv, Sk, Dh)), 'v_cache': _w((lambda *s: torch.randn(*s, dtype=torch.bfloat16) * 3.2)(B, Hkv, Sk, Dh)), 'wq': _w((lambda *s: torch.randn(*s, dtype=torch.bfloat16) * 0.8)(D, Hq * Dh) * D ** (-0.5)), 'wo': _w((lambda *s: torch.randn(*s, dtype=torch.bfloat16) * 3.2)(Hq * Dh, D) * (Hq * Dh) ** (-0.5))}
    _A_in = _A_setup()

    def _B_setup():
        B, S, D, F = (2, 1, 576, 4608)
        return {'x': _w((lambda *s: torch.randn(*s, dtype=torch.bfloat16) * 0.1)(B, S, D)), 'w1': _w((lambda *s: torch.randn(*s, dtype=torch.bfloat16) * 3.2)(D, F) * (2.0 / D) ** 0.5), 'w3': _w((lambda *s: torch.randn(*s, dtype=torch.bfloat16) * 3.2)(D, F) * (2.0 / D) ** 0.5), 'w2': _w((lambda *s: torch.randn(*s, dtype=torch.bfloat16) * 3.2)(F, D) * (2.0 / F) ** 0.5)}
    _B_in = _B_setup()
    return {'A_x': _A_in['x'], 'A_k_cache': _A_in['k_cache'], 'A_v_cache': _A_in['v_cache'], 'A_wq': _A_in['wq'], 'A_wo': _A_in['wo'], 'B_x': _B_in['x'], 'B_w1': _B_in['w1'], 'B_w3': _B_in['w3'], 'B_w2': _B_in['w2'], 'c': _w((lambda *s: torch.randn(*s, dtype=torch.bfloat16) * 0.4)(2, 576) * 8.0), 'w_mod': _w((lambda *s: torch.randn(*s, dtype=torch.bfloat16) * 0.4)(576, 6 * 576) * 576 ** (-0.5) * 8.0)}

def reference(A_x, A_k_cache, A_v_cache, A_wq, A_wo, B_x, B_w1, B_w3, B_w2, c, w_mod):

    def _A_ref(x, k_cache, v_cache, wq, wo):
        B, Sq, D = x.shape
        Hq, Dh = (32, 128)
        Hkv = k_cache.shape[1]
        rep = Hq // Hkv
        q = (lambda x, *d: x.permute(*d))((x @ wq).reshape(B, Sq, Hq, Dh), 0, 2, 1, 3)
        k = (lambda x, n, axis: torch.repeat_interleave(x, n, dim=axis))(k_cache, rep, axis=1)
        v = (lambda x, n, axis: torch.repeat_interleave(x, n, dim=axis))(v_cache, rep, axis=1)
        scores = torch.einsum('bhqd,bhkd->bhqk', q, k) * Dh ** (-0.5)
        p = _softmax(scores, axis=-1)
        o = torch.einsum('bhqk,bhkd->bhqd', p, v)
        return (lambda x, *d: x.permute(*d))(o, 0, 2, 1, 3).reshape(B, Sq, Hq * Dh) @ wo

    def _B_ref(x, w1, w3, w2):
        gate = torch.einsum('bsd,df->bsf', x, w1)
        up = torch.einsum('bsd,df->bsf', x, w3)
        h = _silu(gate) * up
        out = torch.einsum('bsf,fd->bsd', h, w2)
        return out
    x = A_x
    mod = (_silu(c) @ w_mod).reshape(c.shape[0], 6, 1, -1)
    sa, ca, ga, sb, cb, gb = (mod[:, 0].clone(), mod[:, 1].clone(), mod[:, 2].clone(), mod[:, 3].clone(), mod[:, 4].clone(), mod[:, 5].clone())
    h = _layernorm(x, axis=-1) * (1 + ca) + sa
    x = x + ga * _A_ref(h, A_k_cache, A_v_cache, A_wq, A_wo)
    h = _layernorm(x, axis=-1) * (1 + cb) + sb
    x = x + gb * _B_ref(h, B_w1, B_w3, B_w2)
    return x
```

```asm
; @launch grid=(256,1,1) block=(768,1,1) lds=153856
.amdgcn_target "amdgcn-amd-amdhsa--gfx950"
.text
.globl adaLN_cond__gqa_block_cached__glu_gated_swiglu__decode_kernel
.p2align 8
.type adaLN_cond__gqa_block_cached__glu_gated_swiglu__decode_kernel,@function
adaLN_cond__gqa_block_cached__glu_gated_swiglu__decode_kernel:
  s_load_dwordx2 s[8:9], s[0:1], 8
  s_load_dwordx16 s[24:39], s[0:1], 0
  s_load_dwordx8 s[40:47], s[0:1], 64
  s_load_dwordx4 s[48:51], s[0:1], 96
  s_cmp_ge_u32 s2, 256
  s_cbranch_scc1 L_end
  v_readfirstlane_b32 s3, v0
  v_and_b32 v0, 63, v0
  s_lshr_b32 s5, s2, 3
  s_getpc_b64 s[54:55]
  v_lshlrev_b32 v3, 7, v0
  s_mov_b32 exec_hi, 0
  global_load_dword v39, v3, s[54:55]
  s_mov_b64 exec, -1
  s_and_b32 s4, s2, 7
  s_and_b32 s6, s2, 0x80
  s_and_b32 s54, s5, 15
  s_lshl4_add_u32 s54, s4, s54
  s_add_u32 s6, s6, s54
  s_lshl_b32 s54, s3, 4
  s_lshr_b32 s3, s3, 6
  s_cmp_ge_u32 s3, 8
  s_cbranch_scc1 L_H0
  s_lshl_b32 s56, s6, 18
  s_add_u32 s56, s56, s54
  s_xor_b32 s57, s56, 8192
  s_mov_b64 s[58:59], s[56:57]
  s_brev_b32 s10, 32
  s_mov_b32 s11, 0x20000
  v_lshlrev_b32 v1, 4, v0
  s_waitcnt lgkmcnt(0)
  s_movk_i32 s53, 0x87
  s_sub_u32 s54, s5, 24
  s_min_u32 s54, s54, 31
  s_bitcmp1_b32 s53, s54
  s_cbranch_scc1 L_k0a
  buffer_load_dwordx4 v[40:43], v1, s[8:11], s56 offen nt
  s_addk_i32 s56, 16384
  buffer_load_dwordx4 v[44:47], v1, s[8:11], s57 offen nt
  s_addk_i32 s57, 16384
L_k0a:
  s_barrier
  s_branch L_Sq
L_H0:
  s_cmp_eq_u32 s3, 11
  s_cbranch_scc1 L_h3i
  s_mov_b32 s80, 0
  s_sub_u32 s53, 3, s4
  s_and_b32 s53, s53, 7
  s_lshl_b32 s53, s53, 1
  s_sub_u32 s53, s5, s53
  s_add_u32 s53, s53, 4
  s_add_u32 s54, s53, 15
  s_min_u32 s53, s53, s54
  s_sub_u32 s54, s53, 15
  s_min_u32 s53, s53, s54
  s_lshr_b32 s83, s53, 2
  s_and_b32 s53, s53, 3
  s_lshl_b32 s53, s53, 1
  s_lshl3_add_u32 s84, s4, s53
  s_cmp_lt_u32 s5, 9
  s_cselect_b32 s83, 3, s83
  s_sub_u32 s53, s2, 192
  s_sub_u32 s54, s2, 229
  s_cmp_ge_u32 s2, 253
  s_cselect_b32 s54, s54, 27
  s_cmp_lt_u32 s5, 27
  s_cselect_b32 s53, s53, s54
  s_mul_i32 s54, s53, 57
  s_lshr_b32 s54, s54, 9
  s_mul_i32 s55, s54, 9
  s_sub_u32 s53, s53, s55
  s_cmp_lt_u32 s5, 24
  s_cselect_b32 s83, s83, s54
  s_cselect_b32 s84, s84, s53
  s_mul_i32 s86, s83, 3
  s_sub_u32 s56, s3, 8
  s_add_u32 s86, s86, s56
  s_lshl_b32 s53, s86, 7
  v_lshrrev_b32 v13, 5, v0
  v_mul_u32_u24 v2, 1024, v13
  v_lshl_add_u32 v2, v0, 2, v2
  s_movk_i32 s22, 2304
  s_mov_b32 s23, 0x20000
  s_mov_b32 s15, 0x20000
  s_movk_i32 s60, 6912
  s_cmp_lt_u32 s5, 24
  s_cselect_b32 s60, 8192, s60
  s_movk_i32 s59, 1152
  s_cselect_b32 s59, 128, s59
  s_mul_i32 s14, s60, 576
  v_bfe_u32 v12, v0, 4, 2
  v_lshlrev_b32 v12, 1, v12
  v_and_b32 v13, 7, v0
  v_xor_b32 v12, v12, v13
  v_lshrrev_b32 v13, 3, v0
  v_mul_u32_u24 v13, s60, v13
  v_lshl_add_u32 v12, v12, 4, v13
  s_lshl_b32 s60, s60, 3
  s_mul_i32 s61, s86, s60
  s_lshl_b32 s54, s84, 7
  s_lshl3_add_u32 s61, s61, s54
  s_mul_i32 s58, s56, 24576
  s_add_u32 s58, s58, 16384
  s_add_u32 s57, s58, 8192
  s_cmp_lt_u32 s5, 24
  s_waitcnt lgkmcnt(0)
  s_cselect_b32 s20, s24, s42
  s_cselect_b32 s21, s25, s43
  s_cselect_b32 s12, s30, s44
  s_cselect_b32 s13, s31, s45
  buffer_load_dword v16, v2, s[20:23], s53 offen
  s_cbranch_scc0 L_nxe
  s_cmp_lt_u32 s83, 3
  s_cbranch_scc0 L_nxl
  buffer_load_dword v44, v2, s[20:23], 0 offen offset:0
  buffer_load_dword v46, v2, s[20:23], 0 offen offset:128
  buffer_load_dword v48, v2, s[20:23], 0 offen offset:256
  buffer_load_dword v50, v2, s[20:23], 0 offen offset:384
  buffer_load_dword v52, v2, s[20:23], 0 offen offset:512
  buffer_load_dword v54, v2, s[20:23], 0 offen offset:640
  buffer_load_dword v56, v2, s[20:23], 0 offen offset:768
  buffer_load_dword v58, v2, s[20:23], 0 offen offset:896
  buffer_load_dword v60, v2, s[20:23], 0 offen offset:1024
L_nxl:
  s_barrier
L_nxe:
  s_cmp_lt_u32 s83, 3
  s_cbranch_scc0 L_w3d
L_w3:
  s_mov_b32 m0, s58
  s_add_u32 s53, s61, s59
  buffer_load_dwordx4 v12, s[12:15], s61 offen nt lds
  s_add_u32 m0, s58, 8192
  s_add_u32 s58, s58, 1024
  buffer_load_dwordx4 v12, s[12:15], s53 offen nt lds
  s_add_u32 s61, s61, s60
  s_cmp_lg_u32 s58, s57
  s_cbranch_scc1 L_w3
L_w3d:
  s_cmp_lt_u32 s5, 24
  s_cbranch_scc1 L_H
  s_barrier
  s_branch L_H
L_h3i:
  v_lshlrev_b32 v1, 2, v0
  v_mov_b32 v2, 0
  s_getpc_b64 s[54:55]
L_pc:
  s_sub_u32 s54, s54, L_pc-adaLN_cond__gqa_block_cached__glu_gated_swiglu__decode_kernel
  s_subb_u32 s55, s55, 0
  s_lshl_b32 s53, s5, 10
  v_lshl_add_u32 v3, v0, 7, s53
  v_min_u32 v3, L_end-adaLN_cond__gqa_block_cached__glu_gated_swiglu__decode_kernel, v3
  s_mov_b64 exec, 0xff
  global_load_dword v60, v3, s[54:55]
  s_mov_b64 exec, 0xffffff
  ds_write_b32 v1, v2
  s_mov_b64 exec, -1
  s_waitcnt lgkmcnt(0)
  s_barrier
  s_branch L_H3
L_Sq:
  s_mov_b32 s80, 0
  s_bitcmp1_b32 s53, s54
  s_cbranch_scc0 L_k0b
  buffer_load_dwordx4 v[40:43], v1, s[8:11], s56 offen nt
  s_addk_i32 s56, 16384
  buffer_load_dwordx4 v[44:47], v1, s[8:11], s57 offen nt
  s_addk_i32 s57, 16384
L_k0b:
  s_mov_b32 s12, s28
  s_mov_b32 s13, s29
  s_mov_b32 s14, 67108864
  s_mov_b32 s15, 0x20000
  s_mov_b32 s16, s50
  s_mov_b32 s17, s51
  s_mov_b32 s18, 268435456
  s_mov_b32 s19, 0x20000
  s_mov_b32 s76, 0xcccccccc
  s_mov_b32 s77, 0xcccccccc
  s_mov_b32 s78, 0xaaaaaaaa
  s_mov_b32 s79, 0xaaaaaaaa
  v_bfe_u32 v26, v0, 3, 1
  v_mul_u32_u24 v26, 0x0202, v26
  v_add_u32 v26, 0x0100, v26
  v_or_b32 v27, 0x0c0c0000, v26
  v_lshlrev_b32 v26, 16, v26
  v_or_b32 v26, 0x0c0c, v26
  v_cndmask_b32 v26, v27, v26, s[78:79]
  v_bfe_u32 v27, v0, 1, 2
  v_mov_b32 v28, 0x0c0c0c0c
  v_cmp_eq_u32 vcc, 0, v27
  s_nop 1
  v_cndmask_b32 v22, v28, v26, vcc
  v_cmp_eq_u32 vcc, 1, v27
  s_nop 1
  v_cndmask_b32 v23, v28, v26, vcc
  v_cmp_eq_u32 vcc, 2, v27
  s_nop 1
  v_cndmask_b32 v24, v28, v26, vcc
  v_cmp_eq_u32 vcc, 3, v27
  s_nop 1
  v_cndmask_b32 v25, v28, v26, vcc
  s_mov_b32 s7, 0
  s_sub_u32 s53, s5, 9
  s_cmp_lt_u32 s53, 18
  s_cselect_b64 vcc, -1, 0
  s_cmp_ge_u32 s3, 4
  s_cbranch_scc0 L_npr
  s_setprio 1
L_npr:
  s_lshr_b32 s53, s53, 1
  s_add_u32 s53, s53, s4
  s_and_b32 s53, s53, 7
  s_cmp_eq_u32 s53, 3
  s_cselect_b64 vcc, 0, vcc
  buffer_load_dwordx4 v[48:51], v1, s[8:11], s56 offen nt
  s_addk_i32 s56, 16384
  s_waitcnt vmcnt(3)
  buffer_load_dwordx4 v[52:55], v1, s[8:11], s57 offen nt
  s_addk_i32 s57, 16384
  s_waitcnt vmcnt(3)
  buffer_load_dwordx4 v[56:59], v1, s[8:11], s56 offen nt
  s_addk_i32 s56, 16384
  s_waitcnt vmcnt(3)
  buffer_load_dwordx4 v[60:63], v1, s[8:11], s57 offen nt
  s_addk_i32 s57, 16384
  s_waitcnt vmcnt(3)
  buffer_load_dwordx4 v[64:67], v1, s[8:11], s56 offen nt
  s_addk_i32 s56, 16384
  s_waitcnt vmcnt(3)
  buffer_load_dwordx4 v[68:71], v1, s[8:11], s57 offen nt
  s_addk_i32 s57, 16384
  s_waitcnt vmcnt(3)
  buffer_load_dwordx4 v[72:75], v1, s[8:11], s56 offen nt
  s_addk_i32 s56, 16384
  s_waitcnt vmcnt(3)
  buffer_load_dwordx4 v[76:79], v1, s[8:11], s57 offen nt
  s_addk_i32 s57, 16384
  s_waitcnt vmcnt(3)
  buffer_load_dwordx4 v[80:83], v1, s[8:11], s56 offen nt
  s_addk_i32 s56, 16384
  v_mov_b32 v38, 0
  v_mov_b32 v39, 11
  s_mov_b64 exec, 1
  ds_max_u32 v38, v39 offset:36
  s_mov_b64 exec, -1
  s_waitcnt vmcnt(3)
  buffer_load_dwordx4 v[84:87], v1, s[8:11], s57 offen nt
  s_addk_i32 s57, 16384
  s_waitcnt vmcnt(3)
  buffer_load_dwordx4 v[88:91], v1, s[8:11], s56 offen nt
  s_addk_i32 s56, 16384
  s_waitcnt vmcnt(3)
  buffer_load_dwordx4 v[92:95], v1, s[8:11], s57 offen nt
  s_addk_i32 s57, 16384
  v_mov_b32 v38, 0
  v_mov_b32 v39, 14
  s_mov_b64 exec, 1
  ds_max_u32 v38, v39 offset:36
  s_mov_b64 exec, -1
  s_waitcnt vmcnt(3)
  buffer_load_dwordx4 v[96:99], v1, s[8:11], s56 offen nt
  s_addk_i32 s56, 16384
  s_waitcnt vmcnt(3)
  buffer_load_dwordx4 v[100:103], v1, s[8:11], s57 offen nt
  s_addk_i32 s57, 16384
  s_waitcnt vmcnt(3)
  buffer_load_dwordx4 v[104:107], v1, s[8:11], s56 offen nt
  s_addk_i32 s56, 16384
  s_waitcnt vmcnt(3)
  buffer_load_dwordx4 v[108:111], v1, s[8:11], s57 offen nt
  s_addk_i32 s57, 16384
  s_waitcnt vmcnt(3)
  buffer_load_dwordx4 v[112:115], v1, s[8:11], s56 offen nt
  s_addk_i32 s56, 16384
  s_waitcnt vmcnt(3)
  buffer_load_dwordx4 v[116:119], v1, s[8:11], s57 offen nt
  s_addk_i32 s57, 16384
  s_waitcnt vmcnt(3)
  buffer_load_dwordx4 v[120:123], v1, s[8:11], s56 offen nt
  s_addk_i32 s56, 16384
  s_waitcnt vmcnt(3)
  buffer_load_dwordx4 v[124:127], v1, s[8:11], s57 offen nt
  s_addk_i32 s57, 16384
  v_mov_b32 v38, 0
  v_mov_b32 v39, 22
  s_mov_b64 exec, 1
  ds_max_u32 v38, v39 offset:36
  s_mov_b64 exec, -1
  s_waitcnt vmcnt(3)
  buffer_load_dwordx4 v[128:131], v1, s[8:11], s56 offen nt
  s_addk_i32 s56, 16384
  s_waitcnt vmcnt(3)
  buffer_load_dwordx4 v[132:135], v1, s[8:11], s57 offen nt
  s_addk_i32 s57, 16384
  v_mov_b32 v38, 0
  ds_read_b32 v39, v38 offset:64
  s_waitcnt vmcnt(3)
  s_waitcnt lgkmcnt(0)
  v_readfirstlane_b32 s7, v39
  s_nop 0
  s_cmp_eq_u32 s7, 0
  s_cbranch_scc1 L_fb_1
  s_waitcnt vmcnt(2)
L_fb_1:
  buffer_load_dwordx4 v[136:139], v1, s[8:11], s56 offen nt
  s_addk_i32 s56, 16384
  s_waitcnt vmcnt(3)
  s_cmp_eq_u32 s7, 0
  s_cbranch_scc1 L_fb_2
  s_waitcnt vmcnt(2)
L_fb_2:
  buffer_load_dwordx4 v[140:143], v1, s[8:11], s57 offen nt
  s_addk_i32 s57, 16384
  v_mov_b32 v38, 0
  ds_read_b32 v39, v38 offset:64
  s_waitcnt vmcnt(3)
  s_waitcnt lgkmcnt(0)
  v_readfirstlane_b32 s7, v39
  s_nop 0
  s_cmp_eq_u32 s7, 0
  s_cbranch_scc1 L_fb_3
  s_waitcnt vmcnt(2)
L_fb_3:
  buffer_load_dwordx4 v[144:147], v1, s[8:11], s56 offen nt
  s_addk_i32 s56, 16384
  s_waitcnt vmcnt(3)
  s_cmp_eq_u32 s7, 0
  s_cbranch_scc1 L_fb_4
  s_waitcnt vmcnt(2)
L_fb_4:
  buffer_load_dwordx4 v[148:151], v1, s[8:11], s57 offen nt
  s_addk_i32 s57, 16384
  v_mov_b32 v38, 0
  ds_read_b32 v39, v38 offset:64
  s_waitcnt vmcnt(3)
  s_waitcnt lgkmcnt(0)
  v_readfirstlane_b32 s7, v39
  s_nop 0
  s_cmp_eq_u32 s7, 0
  s_cbranch_scc1 L_fb_5
  s_waitcnt vmcnt(2)
L_fb_5:
  buffer_load_dwordx4 v[152:155], v1, s[8:11], s56 offen nt
  s_addk_i32 s56, 16384
  v_mov_b32 v38, 0
  v_mov_b32 v39, 29
  s_mov_b64 exec, 1
  ds_max_u32 v38, v39 offset:36
  s_mov_b64 exec, -1
  s_waitcnt vmcnt(3)
  s_cmp_eq_u32 s7, 0
  s_cbranch_scc1 L_fb_6
  s_waitcnt vmcnt(2)
L_fb_6:
  buffer_load_dwordx4 v[156:159], v1, s[8:11], s57 offen nt
  s_addk_i32 s57, 16384
  v_mov_b32 v38, 0
  ds_read_b32 v39, v38 offset:64
  s_waitcnt vmcnt(3)
  s_waitcnt lgkmcnt(0)
  v_readfirstlane_b32 s7, v39
  s_nop 0
  s_cmp_eq_u32 s7, 0
  s_cbranch_scc1 L_fb_7
  s_waitcnt vmcnt(2)
L_fb_7:
  buffer_load_dwordx4 v[160:163], v1, s[8:11], s56 offen nt
  s_addk_i32 s56, 16384
  s_waitcnt vmcnt(3)
  s_cmp_eq_u32 s7, 0
  s_cbranch_scc1 L_fb_8
  s_waitcnt vmcnt(2)
L_fb_8:
  buffer_load_dwordx4 v[164:167], v1, s[8:11], s57 offen nt
  s_addk_i32 s57, 16384
  v_mov_b32 v38, 0
L_lw_9:
  ds_read_b32 v39, v38 offset:8
  s_waitcnt lgkmcnt(0)
  v_readfirstlane_b32 s53, v39
  s_nop 0
  s_cmp_eq_u32 s53, 1
  s_cbranch_scc1 L_lwd_10
  s_add_u32 s80, s80, 1
  s_cmp_gt_u32 s80, 4000000
  s_cbranch_scc1 L_exit
  s_sleep 1
  s_branch L_lw_9
L_lwd_10:
  v_and_b32 v38, 15, v0
  v_lshlrev_b32 v38, 4, v38
  ds_read_b128 v[2:5], v38 offset:256
  ds_read_b128 v[6:9], v38 offset:512
  s_waitcnt lgkmcnt(0)
  v_dot2_f32_bf16 v10, v40, v2, 0
  v_dot2_f32_bf16 v11, v40, v6, 0
  v_dot2_f32_bf16 v14, v44, v2, 0
  v_dot2_f32_bf16 v18, v44, v6, 0
  v_dot2c_f32_bf16 v10, v41, v3
  v_dot2c_f32_bf16 v11, v41, v7
  v_dot2c_f32_bf16 v14, v45, v3
  v_dot2c_f32_bf16 v18, v45, v7
  v_dot2c_f32_bf16 v10, v42, v4
  v_dot2c_f32_bf16 v11, v42, v8
  v_dot2c_f32_bf16 v14, v46, v4
  v_dot2c_f32_bf16 v18, v46, v8
  v_dot2c_f32_bf16 v10, v43, v5
  v_dot2c_f32_bf16 v11, v43, v9
  v_dot2c_f32_bf16 v14, v47, v5
  v_dot2c_f32_bf16 v18, v47, v9
  v_add_f32_dpp v10, v10, v10 row_ror:8 row_mask:0xf bank_mask:0x3
  v_add_f32_dpp v11, v11, v11 row_ror:8 row_mask:0xf bank_mask:0x3
  s_nop 0
  v_add_f32_dpp v10, v14, v14 row_ror:8 row_mask:0xf bank_mask:0xc
  v_add_f32_dpp v11, v18, v18 row_ror:8 row_mask:0xf bank_mask:0xc
  v_mov_b32 v38, 0
  ds_read_b32 v39, v38 offset:64
  s_waitcnt vmcnt(3)
  s_waitcnt lgkmcnt(0)
  v_readfirstlane_b32 s7, v39
  s_nop 0
  s_cmp_eq_u32 s7, 0
  s_cbranch_scc1 L_fb_11
  s_waitcnt vmcnt(2)
L_fb_11:
  buffer_load_dwordx4 v[40:43], v1, s[12:15], s58 offen nt
  s_addk_i32 s58, 16384
  v_dot2_f32_bf16 v14, v48, v2, 0
  v_dot2_f32_bf16 v18, v48, v6, 0
  v_dot2_f32_bf16 v15, v52, v2, 0
  v_dot2_f32_bf16 v19, v52, v6, 0
  v_dot2c_f32_bf16 v14, v49, v3
  v_dot2c_f32_bf16 v18, v49, v7
  v_dot2c_f32_bf16 v15, v53, v3
  v_dot2c_f32_bf16 v19, v53, v7
  v_dot2c_f32_bf16 v14, v50, v4
  v_dot2c_f32_bf16 v18, v50, v8
  v_dot2c_f32_bf16 v15, v54, v4
  v_dot2c_f32_bf16 v19, v54, v8
  v_dot2c_f32_bf16 v14, v51, v5
  v_dot2c_f32_bf16 v18, v51, v9
  v_dot2c_f32_bf16 v15, v55, v5
  v_dot2c_f32_bf16 v19, v55, v9
  v_add_f32_dpp v14, v14, v14 row_ror:8 row_mask:0xf bank_mask:0x3
  v_add_f32_dpp v18, v18, v18 row_ror:8 row_mask:0xf bank_mask:0x3
  s_nop 0
  v_add_f32_dpp v14, v15, v15 row_ror:8 row_mask:0xf bank_mask:0xc
  v_add_f32_dpp v18, v19, v19 row_ror:8 row_mask:0xf bank_mask:0xc
  v_add_f32_dpp v10, v10, v10 row_shl:4 row_mask:0xf bank_mask:0x5
  v_add_f32_dpp v11, v11, v11 row_shl:4 row_mask:0xf bank_mask:0x5
  s_nop 0
  v_add_f32_dpp v10, v14, v14 row_shr:4 row_mask:0xf bank_mask:0xa
  v_add_f32_dpp v11, v18, v18 row_shr:4 row_mask:0xf bank_mask:0xa
  v_dot2_f32_bf16 v14, v56, v2, 0
  v_dot2_f32_bf16 v18, v56, v6, 0
  v_dot2_f32_bf16 v15, v60, v2, 0
  v_dot2_f32_bf16 v19, v60, v6, 0
  v_dot2c_f32_bf16 v14, v57, v3
  v_dot2c_f32_bf16 v18, v57, v7
  v_dot2c_f32_bf16 v15, v61, v3
  v_dot2c_f32_bf16 v19, v61, v7
  v_dot2c_f32_bf16 v14, v58, v4
  v_dot2c_f32_bf16 v18, v58, v8
  v_dot2c_f32_bf16 v15, v62, v4
  v_dot2c_f32_bf16 v19, v62, v8
  v_dot2c_f32_bf16 v14, v59, v5
  v_dot2c_f32_bf16 v18, v59, v9
  v_dot2c_f32_bf16 v15, v63, v5
  v_dot2c_f32_bf16 v19, v63, v9
  v_add_f32_dpp v14, v14, v14 row_ror:8 row_mask:0xf bank_mask:0x3
  v_add_f32_dpp v18, v18, v18 row_ror:8 row_mask:0xf bank_mask:0x3
  s_nop 0
  v_add_f32_dpp v14, v15, v15 row_ror:8 row_mask:0xf bank_mask:0xc
  v_add_f32_dpp v18, v19, v19 row_ror:8 row_mask:0xf bank_mask:0xc
  v_dot2_f32_bf16 v15, v64, v2, 0
  v_dot2_f32_bf16 v19, v64, v6, 0
  v_dot2_f32_bf16 v16, v68, v2, 0
  v_dot2_f32_bf16 v20, v68, v6, 0
  v_dot2c_f32_bf16 v15, v65, v3
  v_dot2c_f32_bf16 v19, v65, v7
  v_dot2c_f32_bf16 v16, v69, v3
  v_dot2c_f32_bf16 v20, v69, v7
  v_dot2c_f32_bf16 v15, v66, v4
  v_dot2c_f32_bf16 v19, v66, v8
  v_dot2c_f32_bf16 v16, v70, v4
  v_dot2c_f32_bf16 v20, v70, v8
  v_dot2c_f32_bf16 v15, v67, v5
  v_dot2c_f32_bf16 v19, v67, v9
  v_dot2c_f32_bf16 v16, v71, v5
  v_dot2c_f32_bf16 v20, v71, v9
  v_add_f32_dpp v15, v15, v15 row_ror:8 row_mask:0xf bank_mask:0x3
  v_add_f32_dpp v19, v19, v19 row_ror:8 row_mask:0xf bank_mask:0x3
  s_nop 0
  v_add_f32_dpp v15, v16, v16 row_ror:8 row_mask:0xf bank_mask:0xc
  v_add_f32_dpp v19, v20, v20 row_ror:8 row_mask:0xf bank_mask:0xc
  v_add_f32_dpp v14, v14, v14 row_shl:4 row_mask:0xf bank_mask:0x5
  v_add_f32_dpp v18, v18, v18 row_shl:4 row_mask:0xf bank_mask:0x5
  s_nop 0
  v_add_f32_dpp v14, v15, v15 row_shr:4 row_mask:0xf bank_mask:0xa
  v_add_f32_dpp v18, v19, v19 row_shr:4 row_mask:0xf bank_mask:0xa
  v_add_f32_dpp v10, v10, v10 quad_perm:[2,3,0,1] row_mask:0xf bank_mask:0xf
  v_add_f32_dpp v11, v11, v11 quad_perm:[2,3,0,1] row_mask:0xf bank_mask:0xf
  v_add_f32_dpp v14, v14, v14 quad_perm:[2,3,0,1] row_mask:0xf bank_mask:0xf
  v_add_f32_dpp v18, v18, v18 quad_perm:[2,3,0,1] row_mask:0xf bank_mask:0xf
  v_cndmask_b32 v10, v10, v14, s[76:77]
  v_cndmask_b32 v11, v11, v18, s[76:77]
  s_waitcnt vmcnt(3)
  s_cmp_eq_u32 s7, 0
  s_cbranch_scc1 L_fb_12
  s_waitcnt vmcnt(2)
L_fb_12:
  buffer_load_dwordx4 v[44:47], v1, s[12:15], s59 offen nt
  s_addk_i32 s59, 16384
  v_mov_b32 v38, 0
  v_mov_b32 v39, 34
  s_mov_b64 exec, 1
  ds_max_u32 v38, v39 offset:36
  s_mov_b64 exec, -1
  v_dot2_f32_bf16 v14, v72, v2, 0
  v_dot2_f32_bf16 v18, v72, v6, 0
  v_dot2_f32_bf16 v15, v76, v2, 0
  v_dot2_f32_bf16 v19, v76, v6, 0
  v_dot2c_f32_bf16 v14, v73, v3
  v_dot2c_f32_bf16 v18, v73, v7
  v_dot2c_f32_bf16 v15, v77, v3
  v_dot2c_f32_bf16 v19, v77, v7
  v_dot2c_f32_bf16 v14, v74, v4
  v_dot2c_f32_bf16 v18, v74, v8
  v_dot2c_f32_bf16 v15, v78, v4
  v_dot2c_f32_bf16 v19, v78, v8
  v_dot2c_f32_bf16 v14, v75, v5
  v_dot2c_f32_bf16 v18, v75, v9
  v_dot2c_f32_bf16 v15, v79, v5
  v_dot2c_f32_bf16 v19, v79, v9
  v_add_f32_dpp v14, v14, v14 row_ror:8 row_mask:0xf bank_mask:0x3
  v_add_f32_dpp v18, v18, v18 row_ror:8 row_mask:0xf bank_mask:0x3
  s_nop 0
  v_add_f32_dpp v14, v15, v15 row_ror:8 row_mask:0xf bank_mask:0xc
  v_add_f32_dpp v18, v19, v19 row_ror:8 row_mask:0xf bank_mask:0xc
  v_dot2_f32_bf16 v15, v80, v2, 0
  v_dot2_f32_bf16 v19, v80, v6, 0
  v_dot2_f32_bf16 v16, v84, v2, 0
  v_dot2_f32_bf16 v20, v84, v6, 0
  v_dot2c_f32_bf16 v15, v81, v3
  v_dot2c_f32_bf16 v19, v81, v7
  v_dot2c_f32_bf16 v16, v85, v3
  v_dot2c_f32_bf16 v20, v85, v7
  v_dot2c_f32_bf16 v15, v82, v4
  v_dot2c_f32_bf16 v19, v82, v8
  v_dot2c_f32_bf16 v16, v86, v4
  v_dot2c_f32_bf16 v20, v86, v8
  v_dot2c_f32_bf16 v15, v83, v5
  v_dot2c_f32_bf16 v19, v83, v9
  v_dot2c_f32_bf16 v16, v87, v5
  v_dot2c_f32_bf16 v20, v87, v9
  v_add_f32_dpp v15, v15, v15 row_ror:8 row_mask:0xf bank_mask:0x3
  v_add_f32_dpp v19, v19, v19 row_ror:8 row_mask:0xf bank_mask:0x3
  s_nop 0
  v_add_f32_dpp v15, v16, v16 row_ror:8 row_mask:0xf bank_mask:0xc
  v_add_f32_dpp v19, v20, v20 row_ror:8 row_mask:0xf bank_mask:0xc
  v_add_f32_dpp v14, v14, v14 row_shl:4 row_mask:0xf bank_mask:0x5
  v_add_f32_dpp v18, v18, v18 row_shl:4 row_mask:0xf bank_mask:0x5
  s_nop 0
  v_add_f32_dpp v14, v15, v15 row_shr:4 row_mask:0xf bank_mask:0xa
  v_add_f32_dpp v18, v19, v19 row_shr:4 row_mask:0xf bank_mask:0xa
  v_dot2_f32_bf16 v15, v88, v2, 0
  v_dot2_f32_bf16 v19, v88, v6, 0
  v_dot2_f32_bf16 v16, v92, v2, 0
  v_dot2_f32_bf16 v20, v92, v6, 0
  v_dot2c_f32_bf16 v15, v89, v3
  v_dot2c_f32_bf16 v19, v89, v7
  v_dot2c_f32_bf16 v16, v93, v3
  v_dot2c_f32_bf16 v20, v93, v7
  v_dot2c_f32_bf16 v15, v90, v4
  v_dot2c_f32_bf16 v19, v90, v8
  v_dot2c_f32_bf16 v16, v94, v4
  v_dot2c_f32_bf16 v20, v94, v8
  v_dot2c_f32_bf16 v15, v91, v5
  v_dot2c_f32_bf16 v19, v91, v9
  v_dot2c_f32_bf16 v16, v95, v5
  v_dot2c_f32_bf16 v20, v95, v9
  v_add_f32_dpp v15, v15, v15 row_ror:8 row_mask:0xf bank_mask:0x3
  v_add_f32_dpp v19, v19, v19 row_ror:8 row_mask:0xf bank_mask:0x3
  s_nop 0
  v_add_f32_dpp v15, v16, v16 row_ror:8 row_mask:0xf bank_mask:0xc
  v_add_f32_dpp v19, v20, v20 row_ror:8 row_mask:0xf bank_mask:0xc
  v_mov_b32 v38, 0
  ds_read_b32 v39, v38 offset:64
  s_waitcnt vmcnt(3)
  s_waitcnt lgkmcnt(0)
  v_readfirstlane_b32 s7, v39
  s_nop 0
  s_cmp_eq_u32 s7, 0
  s_cbranch_scc1 L_fb_13
  s_waitcnt vmcnt(2)
L_fb_13:
  buffer_load_dwordx4 v[48:51], v1, s[12:15], s58 offen nt
  s_addk_i32 s58, 16384
  v_dot2_f32_bf16 v16, v96, v2, 0
  v_dot2_f32_bf16 v20, v96, v6, 0
  v_dot2_f32_bf16 v17, v100, v2, 0
  v_dot2_f32_bf16 v21, v100, v6, 0
  v_dot2c_f32_bf16 v16, v97, v3
  v_dot2c_f32_bf16 v20, v97, v7
  v_dot2c_f32_bf16 v17, v101, v3
  v_dot2c_f32_bf16 v21, v101, v7
  v_dot2c_f32_bf16 v16, v98, v4
  v_dot2c_f32_bf16 v20, v98, v8
  v_dot2c_f32_bf16 v17, v102, v4
  v_dot2c_f32_bf16 v21, v102, v8
  v_dot2c_f32_bf16 v16, v99, v5
  v_dot2c_f32_bf16 v20, v99, v9
  v_dot2c_f32_bf16 v17, v103, v5
  v_dot2c_f32_bf16 v21, v103, v9
  v_add_f32_dpp v16, v16, v16 row_ror:8 row_mask:0xf bank_mask:0x3
  v_add_f32_dpp v20, v20, v20 row_ror:8 row_mask:0xf bank_mask:0x3
  s_nop 0
  v_add_f32_dpp v16, v17, v17 row_ror:8 row_mask:0xf bank_mask:0xc
  v_add_f32_dpp v20, v21, v21 row_ror:8 row_mask:0xf bank_mask:0xc
  v_add_f32_dpp v15, v15, v15 row_shl:4 row_mask:0xf bank_mask:0x5
  v_add_f32_dpp v19, v19, v19 row_shl:4 row_mask:0xf bank_mask:0x5
  s_nop 0
  v_add_f32_dpp v15, v16, v16 row_shr:4 row_mask:0xf bank_mask:0xa
  v_add_f32_dpp v19, v20, v20 row_shr:4 row_mask:0xf bank_mask:0xa
  v_add_f32_dpp v14, v14, v14 quad_perm:[2,3,0,1] row_mask:0xf bank_mask:0xf
  v_add_f32_dpp v18, v18, v18 quad_perm:[2,3,0,1] row_mask:0xf bank_mask:0xf
  v_add_f32_dpp v15, v15, v15 quad_perm:[2,3,0,1] row_mask:0xf bank_mask:0xf
  v_add_f32_dpp v19, v19, v19 quad_perm:[2,3,0,1] row_mask:0xf bank_mask:0xf
  v_cndmask_b32 v14, v14, v15, s[76:77]
  v_cndmask_b32 v18, v18, v19, s[76:77]
  v_add_f32_dpp v10, v10, v10 quad_perm:[1,0,3,2] row_mask:0xf bank_mask:0xf
  v_add_f32_dpp v11, v11, v11 quad_perm:[1,0,3,2] row_mask:0xf bank_mask:0xf
  v_add_f32_dpp v14, v14, v14 quad_perm:[1,0,3,2] row_mask:0xf bank_mask:0xf
  v_add_f32_dpp v18, v18, v18 quad_perm:[1,0,3,2] row_mask:0xf bank_mask:0xf
  v_cndmask_b32 v10, v10, v14, s[78:79]
  v_cndmask_b32 v11, v11, v18, s[78:79]
  v_dot2_f32_bf16 v12, v104, v2, 0
  v_dot2_f32_bf16 v13, v104, v6, 0
  v_dot2_f32_bf16 v14, v108, v2, 0
  v_dot2_f32_bf16 v18, v108, v6, 0
  v_dot2c_f32_bf16 v12, v105, v3
  v_dot2c_f32_bf16 v13, v105, v7
  v_dot2c_f32_bf16 v14, v109, v3
  v_dot2c_f32_bf16 v18, v109, v7
  v_dot2c_f32_bf16 v12, v106, v4
  v_dot2c_f32_bf16 v13, v106, v8
  v_dot2c_f32_bf16 v14, v110, v4
  v_dot2c_f32_bf16 v18, v110, v8
  v_dot2c_f32_bf16 v12, v107, v5
  v_dot2c_f32_bf16 v13, v107, v9
  v_dot2c_f32_bf16 v14, v111, v5
  v_dot2c_f32_bf16 v18, v111, v9
  v_add_f32_dpp v12, v12, v12 row_ror:8 row_mask:0xf bank_mask:0x3
  v_add_f32_dpp v13, v13, v13 row_ror:8 row_mask:0xf bank_mask:0x3
  s_nop 0
  v_add_f32_dpp v12, v14, v14 row_ror:8 row_mask:0xf bank_mask:0xc
  v_add_f32_dpp v13, v18, v18 row_ror:8 row_mask:0xf bank_mask:0xc
  v_dot2_f32_bf16 v14, v112, v2, 0
  v_dot2_f32_bf16 v18, v112, v6, 0
  v_dot2_f32_bf16 v15, v116, v2, 0
  v_dot2_f32_bf16 v19, v116, v6, 0
  v_dot2c_f32_bf16 v14, v113, v3
  v_dot2c_f32_bf16 v18, v113, v7
  v_dot2c_f32_bf16 v15, v117, v3
  v_dot2c_f32_bf16 v19, v117, v7
  v_dot2c_f32_bf16 v14, v114, v4
  v_dot2c_f32_bf16 v18, v114, v8
  v_dot2c_f32_bf16 v15, v118, v4
  v_dot2c_f32_bf16 v19, v118, v8
  v_dot2c_f32_bf16 v14, v115, v5
  v_dot2c_f32_bf16 v18, v115, v9
  v_dot2c_f32_bf16 v15, v119, v5
  v_dot2c_f32_bf16 v19, v119, v9
  v_add_f32_dpp v14, v14, v14 row_ror:8 row_mask:0xf bank_mask:0x3
  v_add_f32_dpp v18, v18, v18 row_ror:8 row_mask:0xf bank_mask:0x3
  s_nop 0
  v_add_f32_dpp v14, v15, v15 row_ror:8 row_mask:0xf bank_mask:0xc
  v_add_f32_dpp v18, v19, v19 row_ror:8 row_mask:0xf bank_mask:0xc
  v_add_f32_dpp v12, v12, v12 row_shl:4 row_mask:0xf bank_mask:0x5
  v_add_f32_dpp v13, v13, v13 row_shl:4 row_mask:0xf bank_mask:0x5
  s_nop 0
  v_add_f32_dpp v12, v14, v14 row_shr:4 row_mask:0xf bank_mask:0xa
  v_add_f32_dpp v13, v18, v18 row_shr:4 row_mask:0xf bank_mask:0xa
  s_waitcnt vmcnt(3)
  s_cmp_eq_u32 s7, 0
  s_cbranch_scc1 L_fb_14
  s_waitcnt vmcnt(2)
L_fb_14:
  buffer_load_dwordx4 v[52:55], v1, s[12:15], s59 offen nt
  s_addk_i32 s59, 16384
  v_dot2_f32_bf16 v14, v120, v2, 0
  v_dot2_f32_bf16 v18, v120, v6, 0
  v_dot2_f32_bf16 v15, v124, v2, 0
  v_dot2_f32_bf16 v19, v124, v6, 0
  v_dot2c_f32_bf16 v14, v121, v3
  v_dot2c_f32_bf16 v18, v121, v7
  v_dot2c_f32_bf16 v15, v125, v3
  v_dot2c_f32_bf16 v19, v125, v7
  v_dot2c_f32_bf16 v14, v122, v4
  v_dot2c_f32_bf16 v18, v122, v8
  v_dot2c_f32_bf16 v15, v126, v4
  v_dot2c_f32_bf16 v19, v126, v8
  v_dot2c_f32_bf16 v14, v123, v5
  v_dot2c_f32_bf16 v18, v123, v9
  v_dot2c_f32_bf16 v15, v127, v5
  v_dot2c_f32_bf16 v19, v127, v9
  v_add_f32_dpp v14, v14, v14 row_ror:8 row_mask:0xf bank_mask:0x3
  v_add_f32_dpp v18, v18, v18 row_ror:8 row_mask:0xf bank_mask:0x3
  s_nop 0
  v_add_f32_dpp v14, v15, v15 row_ror:8 row_mask:0xf bank_mask:0xc
  v_add_f32_dpp v18, v19, v19 row_ror:8 row_mask:0xf bank_mask:0xc
  v_dot2_f32_bf16 v15, v128, v2, 0
  v_dot2_f32_bf16 v19, v128, v6, 0
  v_dot2_f32_bf16 v16, v132, v2, 0
  v_dot2_f32_bf16 v20, v132, v6, 0
  v_dot2c_f32_bf16 v15, v129, v3
  v_dot2c_f32_bf16 v19, v129, v7
  v_dot2c_f32_bf16 v16, v133, v3
  v_dot2c_f32_bf16 v20, v133, v7
  v_dot2c_f32_bf16 v15, v130, v4
  v_dot2c_f32_bf16 v19, v130, v8
  v_dot2c_f32_bf16 v16, v134, v4
  v_dot2c_f32_bf16 v20, v134, v8
  v_dot2c_f32_bf16 v15, v131, v5
  v_dot2c_f32_bf16 v19, v131, v9
  v_dot2c_f32_bf16 v16, v135, v5
  v_dot2c_f32_bf16 v20, v135, v9
  v_add_f32_dpp v15, v15, v15 row_ror:8 row_mask:0xf bank_mask:0x3
  v_add_f32_dpp v19, v19, v19 row_ror:8 row_mask:0xf bank_mask:0x3
  s_nop 0
  v_add_f32_dpp v15, v16, v16 row_ror:8 row_mask:0xf bank_mask:0xc
  v_add_f32_dpp v19, v20, v20 row_ror:8 row_mask:0xf bank_mask:0xc
  v_add_f32_dpp v14, v14, v14 row_shl:4 row_mask:0xf bank_mask:0x5
  v_add_f32_dpp v18, v18, v18 row_shl:4 row_mask:0xf bank_mask:0x5
  s_nop 0
  v_add_f32_dpp v14, v15, v15 row_shr:4 row_mask:0xf bank_mask:0xa
  v_add_f32_dpp v18, v19, v19 row_shr:4 row_mask:0xf bank_mask:0xa
  v_add_f32_dpp v12, v12, v12 quad_perm:[2,3,0,1] row_mask:0xf bank_mask:0xf
  v_add_f32_dpp v13, v13, v13 quad_perm:[2,3,0,1] row_mask:0xf bank_mask:0xf
  v_add_f32_dpp v14, v14, v14 quad_perm:[2,3,0,1] row_mask:0xf bank_mask:0xf
  v_add_f32_dpp v18, v18, v18 quad_perm:[2,3,0,1] row_mask:0xf bank_mask:0xf
  v_cndmask_b32 v12, v12, v14, s[76:77]
  v_cndmask_b32 v13, v13, v18, s[76:77]
  v_dot2_f32_bf16 v14, v136, v2, 0
  v_dot2_f32_bf16 v18, v136, v6, 0
  v_dot2_f32_bf16 v15, v140, v2, 0
  v_dot2_f32_bf16 v19, v140, v6, 0
  v_dot2c_f32_bf16 v14, v137, v3
  v_dot2c_f32_bf16 v18, v137, v7
  v_dot2c_f32_bf16 v15, v141, v3
  v_dot2c_f32_bf16 v19, v141, v7
  v_dot2c_f32_bf16 v14, v138, v4
  v_dot2c_f32_bf16 v18, v138, v8
  v_dot2c_f32_bf16 v15, v142, v4
  v_dot2c_f32_bf16 v19, v142, v8
  v_dot2c_f32_bf16 v14, v139, v5
  v_dot2c_f32_bf16 v18, v139, v9
  v_dot2c_f32_bf16 v15, v143, v5
  v_dot2c_f32_bf16 v19, v143, v9
  v_add_f32_dpp v14, v14, v14 row_ror:8 row_mask:0xf bank_mask:0x3
  v_add_f32_dpp v18, v18, v18 row_ror:8 row_mask:0xf bank_mask:0x3
  s_nop 0
  v_add_f32_dpp v14, v15, v15 row_ror:8 row_mask:0xf bank_mask:0xc
  v_add_f32_dpp v18, v19, v19 row_ror:8 row_mask:0xf bank_mask:0xc
  v_mov_b32 v38, 0
  ds_read_b32 v39, v38 offset:64
  s_waitcnt vmcnt(3)
  s_waitcnt lgkmcnt(0)
  v_readfirstlane_b32 s7, v39
  s_nop 0
  s_cmp_eq_u32 s7, 0
  s_cbranch_scc1 L_fb_15
  s_waitcnt vmcnt(2)
L_fb_15:
  buffer_load_dwordx4 v[56:59], v1, s[12:15], s58 offen nt
  s_addk_i32 s58, 16384
  v_dot2_f32_bf16 v15, v144, v2, 0
  v_dot2_f32_bf16 v19, v144, v6, 0
  v_dot2_f32_bf16 v16, v148, v2, 0
  v_dot2_f32_bf16 v20, v148, v6, 0
  v_dot2c_f32_bf16 v15, v145, v3
  v_dot2c_f32_bf16 v19, v145, v7
  v_dot2c_f32_bf16 v16, v149, v3
  v_dot2c_f32_bf16 v20, v149, v7
  v_dot2c_f32_bf16 v15, v146, v4
  v_dot2c_f32_bf16 v19, v146, v8
  v_dot2c_f32_bf16 v16, v150, v4
  v_dot2c_f32_bf16 v20, v150, v8
  v_dot2c_f32_bf16 v15, v147, v5
  v_dot2c_f32_bf16 v19, v147, v9
  v_dot2c_f32_bf16 v16, v151, v5
  v_dot2c_f32_bf16 v20, v151, v9
  v_add_f32_dpp v15, v15, v15 row_ror:8 row_mask:0xf bank_mask:0x3
  v_add_f32_dpp v19, v19, v19 row_ror:8 row_mask:0xf bank_mask:0x3
  s_nop 0
  v_add_f32_dpp v15, v16, v16 row_ror:8 row_mask:0xf bank_mask:0xc
  v_add_f32_dpp v19, v20, v20 row_ror:8 row_mask:0xf bank_mask:0xc
  v_add_f32_dpp v14, v14, v14 row_shl:4 row_mask:0xf bank_mask:0x5
  v_add_f32_dpp v18, v18, v18 row_shl:4 row_mask:0xf bank_mask:0x5
  s_nop 0
  v_add_f32_dpp v14, v15, v15 row_shr:4 row_mask:0xf bank_mask:0xa
  v_add_f32_dpp v18, v19, v19 row_shr:4 row_mask:0xf bank_mask:0xa
  v_dot2_f32_bf16 v15, v152, v2, 0
  v_dot2_f32_bf16 v19, v152, v6, 0
  v_dot2_f32_bf16 v16, v156, v2, 0
  v_dot2_f32_bf16 v20, v156, v6, 0
  v_dot2c_f32_bf16 v15, v153, v3
  v_dot2c_f32_bf16 v19, v153, v7
  v_dot2c_f32_bf16 v16, v157, v3
  v_dot2c_f32_bf16 v20, v157, v7
  v_dot2c_f32_bf16 v15, v154, v4
  v_dot2c_f32_bf16 v19, v154, v8
  v_dot2c_f32_bf16 v16, v158, v4
  v_dot2c_f32_bf16 v20, v158, v8
  v_dot2c_f32_bf16 v15, v155, v5
  v_dot2c_f32_bf16 v19, v155, v9
  v_dot2c_f32_bf16 v16, v159, v5
  v_dot2c_f32_bf16 v20, v159, v9
  v_add_f32_dpp v15, v15, v15 row_ror:8 row_mask:0xf bank_mask:0x3
  v_add_f32_dpp v19, v19, v19 row_ror:8 row_mask:0xf bank_mask:0x3
  s_nop 0
  v_add_f32_dpp v15, v16, v16 row_ror:8 row_mask:0xf bank_mask:0xc
  v_add_f32_dpp v19, v20, v20 row_ror:8 row_mask:0xf bank_mask:0xc
  v_dot2_f32_bf16 v16, v160, v2, 0
  v_dot2_f32_bf16 v20, v160, v6, 0
  v_dot2_f32_bf16 v17, v164, v2, 0
  v_dot2_f32_bf16 v21, v164, v6, 0
  v_dot2c_f32_bf16 v16, v161, v3
  v_dot2c_f32_bf16 v20, v161, v7
  v_dot2c_f32_bf16 v17, v165, v3
  v_dot2c_f32_bf16 v21, v165, v7
  v_dot2c_f32_bf16 v16, v162, v4
  v_dot2c_f32_bf16 v20, v162, v8
  v_dot2c_f32_bf16 v17, v166, v4
  v_dot2c_f32_bf16 v21, v166, v8
  v_dot2c_f32_bf16 v16, v163, v5
  v_dot2c_f32_bf16 v20, v163, v9
  v_dot2c_f32_bf16 v17, v167, v5
  v_dot2c_f32_bf16 v21, v167, v9
  v_add_f32_dpp v16, v16, v16 row_ror:8 row_mask:0xf bank_mask:0x3
  v_add_f32_dpp v20, v20, v20 row_ror:8 row_mask:0xf bank_mask:0x3
  s_nop 0
  v_add_f32_dpp v16, v17, v17 row_ror:8 row_mask:0xf bank_mask:0xc
  v_add_f32_dpp v20, v21, v21 row_ror:8 row_mask:0xf bank_mask:0xc
  v_add_f32_dpp v15, v15, v15 row_shl:4 row_mask:0xf bank_mask:0x5
  v_add_f32_dpp v19, v19, v19 row_shl:4 row_mask:0xf bank_mask:0x5
  s_nop 0
  v_add_f32_dpp v15, v16, v16 row_shr:4 row_mask:0xf bank_mask:0xa
  v_add_f32_dpp v19, v20, v20 row_shr:4 row_mask:0xf bank_mask:0xa
  v_add_f32_dpp v14, v14, v14 quad_perm:[2,3,0,1] row_mask:0xf bank_mask:0xf
  v_add_f32_dpp v18, v18, v18 quad_perm:[2,3,0,1] row_mask:0xf bank_mask:0xf
  v_add_f32_dpp v15, v15, v15 quad_perm:[2,3,0,1] row_mask:0xf bank_mask:0xf
  v_add_f32_dpp v19, v19, v19 quad_perm:[2,3,0,1] row_mask:0xf bank_mask:0xf
  v_cndmask_b32 v14, v14, v15, s[76:77]
  v_cndmask_b32 v18, v18, v19, s[76:77]
  v_add_f32_dpp v12, v12, v12 quad_perm:[1,0,3,2] row_mask:0xf bank_mask:0xf
  v_add_f32_dpp v13, v13, v13 quad_perm:[1,0,3,2] row_mask:0xf bank_mask:0xf
  v_add_f32_dpp v14, v14, v14 quad_perm:[1,0,3,2] row_mask:0xf bank_mask:0xf
  v_add_f32_dpp v18, v18, v18 quad_perm:[1,0,3,2] row_mask:0xf bank_mask:0xf
  v_cndmask_b32 v12, v12, v14, s[78:79]
  v_cndmask_b32 v13, v13, v18, s[78:79]
  s_waitcnt vmcnt(3)
  s_cmp_eq_u32 s7, 0
  s_cbranch_scc1 L_fb_16
  s_waitcnt vmcnt(2)
L_fb_16:
  buffer_load_dwordx4 v[60:63], v1, s[12:15], s59 offen nt
  s_addk_i32 s59, 16384
  s_mov_b32 s53, 0x3db504f3
  s_mov_b32 s54, 0x3fb8aa3b
  v_cvt_pk_bf16_f32 v14, v10, v11
  v_lshlrev_b32 v10, 16, v14
  v_and_b32 v11, 0xffff0000, v14
  v_mul_f32 v10, s53, v10
  v_mul_f32 v11, s53, v11
  v_cvt_pk_bf16_f32 v14, v10, v11
  v_lshlrev_b32 v10, 16, v14
  v_and_b32 v11, 0xffff0000, v14
  v_cvt_pk_bf16_f32 v14, v12, v13
  v_lshlrev_b32 v12, 16, v14
  v_and_b32 v13, 0xffff0000, v14
  v_mul_f32 v12, s53, v12
  v_mul_f32 v13, s53, v13
  v_cvt_pk_bf16_f32 v14, v12, v13
  v_lshlrev_b32 v12, 16, v14
  v_and_b32 v13, 0xffff0000, v14
  v_max_f32 v14, v10, v12
  v_max_f32 v15, v11, v13
  s_nop 1
  v_permlane32_swap_b32 v14, v15
  v_max_f32 v14, v14, v15
  v_mov_b32 v15, v14
  s_nop 1
  v_permlane16_swap_b32 v14, v15
  v_max_f32 v14, v14, v15
  s_nop 1
  v_max_f32_dpp v14, v14, v14 row_ror:8 row_mask:0xf bank_mask:0xf
  s_nop 1
  v_max_f32_dpp v14, v14, v14 row_ror:4 row_mask:0xf bank_mask:0xf
  s_nop 1
  v_max_f32_dpp v14, v14, v14 row_ror:2 row_mask:0xf bank_mask:0xf
  s_nop 1
  v_max_f32_dpp v14, v14, v14 row_ror:1 row_mask:0xf bank_mask:0xf
  s_nop 0
  v_readlane_b32 s60, v14, 0
  v_readlane_b32 s61, v14, 32
  s_nop 0
  v_subrev_f32 v16, s60, v10
  v_mul_f32 v16, s54, v16
  v_exp_f32 v16, v16
  v_subrev_f32 v17, s61, v11
  v_mul_f32 v17, s54, v17
  v_exp_f32 v17, v17
  v_subrev_f32 v18, s60, v12
  v_mul_f32 v18, s54, v18
  v_exp_f32 v18, v18
  v_subrev_f32 v19, s61, v13
  v_mul_f32 v19, s54, v19
  v_exp_f32 v19, v19
  v_add_f32 v15, v16, v18
  v_add_f32 v16, v17, v19
  s_nop 1
  v_permlane32_swap_b32 v15, v16
  v_add_f32 v15, v15, v16
  v_mov_b32 v16, v15
  s_nop 1
  v_permlane16_swap_b32 v15, v16
  v_add_f32 v15, v15, v16
  s_nop 1
  v_add_f32_dpp v15, v15, v15 row_ror:8 row_mask:0xf bank_mask:0xf
  s_nop 1
  v_add_f32_dpp v15, v15, v15 row_ror:4 row_mask:0xf bank_mask:0xf
  s_nop 1
  v_add_f32_dpp v15, v15, v15 row_ror:2 row_mask:0xf bank_mask:0xf
  s_nop 1
  v_add_f32_dpp v15, v15, v15 row_ror:1 row_mask:0xf bank_mask:0xf
  v_lshrrev_b32 v16, 5, v0
  v_lshlrev_b32 v16, 3, v16
  s_lshl_b32 s55, s3, 4
  v_add_u32 v16, s55, v16
  s_mov_b32 exec_lo, 1
  s_mov_b32 exec_hi, 1
  ds_write_b64 v16, v[14:15] offset:128
  s_mov_b64 exec, -1
  v_mov_b32 v38, 0
  v_mov_b32 v39, 1
  s_mov_b64 exec, 1
  ds_add_u32 v38, v39 offset:12
  s_mov_b64 exec, -1
  v_mov_b32 v38, 0
L_lw_17:
  ds_read_b32 v39, v38 offset:4
  s_waitcnt lgkmcnt(0)
  v_readfirstlane_b32 s53, v39
  s_nop 0
  s_cmp_eq_u32 s53, 1
  s_cbranch_scc1 L_lwd_18
  s_add_u32 s80, s80, 1
  s_cmp_gt_u32 s80, 4000000
  s_cbranch_scc1 L_exit
  s_sleep 1
  s_branch L_lw_17
L_lwd_18:
  ds_read_b32 v39, v38 offset:0
  s_waitcnt lgkmcnt(0)
  v_readfirstlane_b32 s52, v39
  s_nop 0
  s_and_b32 s87, s52, 0xff
  s_mul_i32 s88, s87, 0x01010101
  s_xor_b32 s88, s88, 0xe19c3500
  v_mov_b32 v3, s88
  s_mov_b32 s89, 0
  s_mov_b32 s26, 0x7060500
  s_bfe_u32 s30, s88, 0x80000
  s_mov_b32 s27, 0x7060501
  s_bfe_u32 s31, s88, 0x80008
  s_mov_b32 s28, 0x7060502
  s_bfe_u32 s32, s88, 0x80010
  s_mov_b32 s29, 0x7060503
  s_bfe_u32 s33, s88, 0x80018
  v_and_b32 v2, 15, v0
  v_lshlrev_b32 v2, 4, v2
  v_bfe_u32 v4, v0, 4, 1
  v_lshl_add_u32 v2, v4, 10, v2
  v_lshrrev_b32 v4, 5, v0
  v_lshl_add_u32 v2, v4, 17, v2
  s_lshl_b32 s62, s4, 14
  s_lshr_b32 s53, s3, 2
  s_lshl_b32 s53, s53, 13
  s_add_u32 s62, s62, s53
  s_and_b32 s53, s3, 3
  s_lshl_b32 s53, s53, 8
  s_add_u32 s62, s62, s53
  s_add_u32 s62, s62, 131072
  s_add_u32 s63, s62, 4096
  v_mov_b32 v38, 0
  ds_read_b32 v39, v38 offset:64
  s_waitcnt vmcnt(3)
  s_waitcnt lgkmcnt(0)
  v_readfirstlane_b32 s7, v39
  s_nop 0
  s_cmp_eq_u32 s7, 0
  s_cbranch_scc1 L_fb_19
  s_waitcnt vmcnt(2)
L_fb_19:
  buffer_load_dwordx4 v[64:67], v1, s[12:15], s58 offen nt
  s_addk_i32 s58, 16384
  s_waitcnt vmcnt(3)
  s_cmp_eq_u32 s7, 0
  s_cbranch_scc1 L_fb_20
  s_waitcnt vmcnt(2)
L_fb_20:
  buffer_load_dwordx4 v[68:71], v1, s[12:15], s59 offen nt
  s_addk_i32 s59, 16384
  v_mov_b32 v38, 0
  ds_read_b32 v39, v38 offset:64
  s_waitcnt vmcnt(3)
  s_waitcnt lgkmcnt(0)
  v_readfirstlane_b32 s7, v39
  s_nop 0
  s_cmp_eq_u32 s7, 0
  s_cbranch_scc1 L_fb_21
  s_waitcnt vmcnt(2)
L_fb_21:
  buffer_load_dwordx4 v[72:75], v1, s[12:15], s58 offen nt
  s_addk_i32 s58, 16384
  s_waitcnt vmcnt(3)
  s_cmp_eq_u32 s7, 0
  s_cbranch_scc1 L_fb_22
  s_waitcnt vmcnt(2)
L_fb_22:
  buffer_load_dwordx4 v[76:79], v1, s[12:15], s59 offen nt
  s_addk_i32 s59, 16384
  v_mov_b32 v38, 0
  ds_read_b32 v39, v38 offset:64
  s_waitcnt vmcnt(3)
  s_waitcnt lgkmcnt(0)
  v_readfirstlane_b32 s7, v39
  s_nop 0
  s_cmp_eq_u32 s7, 0
  s_cbranch_scc1 L_fb_23
  s_waitcnt vmcnt(2)
L_fb_23:
  buffer_load_dwordx4 v[80:83], v1, s[12:15], s58 offen nt
  s_addk_i32 s58, 16384
  s_waitcnt vmcnt(3)
  s_cmp_eq_u32 s7, 0
  s_cbranch_scc1 L_fb_24
  s_waitcnt vmcnt(2)
L_fb_24:
  buffer_load_dwordx4 v[84:87], v1, s[12:15], s59 offen nt
  s_addk_i32 s59, 16384
  v_mov_b32 v38, 0
  ds_read_b32 v39, v38 offset:64
  s_waitcnt vmcnt(3)
  s_waitcnt lgkmcnt(0)
  v_readfirstlane_b32 s7, v39
  s_nop 0
  s_cmp_eq_u32 s7, 0
  s_cbranch_scc1 L_fb_25
  s_waitcnt vmcnt(2)
L_fb_25:
  buffer_load_dwordx4 v[88:91], v1, s[12:15], s58 offen nt
  s_addk_i32 s58, 16384
  s_waitcnt vmcnt(3)
  s_cmp_eq_u32 s7, 0
  s_cbranch_scc1 L_fb_26
  s_waitcnt vmcnt(2)
L_fb_26:
  buffer_load_dwordx4 v[92:95], v1, s[12:15], s59 offen nt
  s_addk_i32 s59, 16384
  v_mov_b32 v38, 0
  v_mov_b32 v39, 46
  s_mov_b64 exec, 1
  ds_max_u32 v38, v39 offset:36
  s_mov_b64 exec, -1
  v_mov_b32 v38, 0
  ds_read_b32 v39, v38 offset:64
  s_waitcnt vmcnt(3)
  s_waitcnt lgkmcnt(0)
  v_readfirstlane_b32 s7, v39
  s_nop 0
  s_cmp_eq_u32 s7, 0
  s_cbranch_scc1 L_fb_27
  s_waitcnt vmcnt(2)
L_fb_27:
  buffer_load_dwordx4 v[96:99], v1, s[12:15], s58 offen nt
  s_addk_i32 s58, 16384
  s_waitcnt vmcnt(3)
  s_cmp_eq_u32 s7, 0
  s_cbranch_scc1 L_fb_28
  s_waitcnt vmcnt(2)
L_fb_28:
  buffer_load_dwordx4 v[100:103], v1, s[12:15], s59 offen nt
  s_addk_i32 s59, 16384
  v_mov_b32 v38, 0
  ds_read_b32 v39, v38 offset:64
  s_waitcnt vmcnt(3)
  s_waitcnt lgkmcnt(0)
  v_readfirstlane_b32 s7, v39
  s_nop 0
  s_cmp_eq_u32 s7, 0
  s_cbranch_scc1 L_fb_29
  s_waitcnt vmcnt(2)
L_fb_29:
  buffer_load_dwordx4 v[104:107], v1, s[12:15], s58 offen nt
  s_addk_i32 s58, 16384
  s_waitcnt vmcnt(3)
  s_cmp_eq_u32 s7, 0
  s_cbranch_scc1 L_fb_30
  s_waitcnt vmcnt(2)
L_fb_30:
  buffer_load_dwordx4 v[108:111], v1, s[12:15], s59 offen nt
  s_addk_i32 s59, 16384
  v_mov_b32 v38, 0
  ds_read_b32 v39, v38 offset:64
  s_waitcnt vmcnt(3)
  s_waitcnt lgkmcnt(0)
  v_readfirstlane_b32 s7, v39
  s_nop 0
  s_cmp_eq_u32 s7, 0
  s_cbranch_scc1 L_fb_31
  s_waitcnt vmcnt(2)
L_fb_31:
  buffer_load_dwordx4 v[112:115], v1, s[12:15], s58 offen nt
  s_addk_i32 s58, 16384
  v_mov_b32 v38, 0
  v_mov_b32 v39, 51
  s_mov_b64 exec, 1
  ds_max_u32 v38, v39 offset:36
  s_mov_b64 exec, -1
  s_waitcnt vmcnt(3)
  s_cmp_eq_u32 s7, 0
  s_cbranch_scc1 L_fb_32
  s_waitcnt vmcnt(2)
L_fb_32:
  buffer_load_dwordx4 v[116:119], v1, s[12:15], s59 offen nt
  s_addk_i32 s59, 16384
  v_mov_b32 v38, 0
  ds_read_b32 v39, v38 offset:64
  s_waitcnt vmcnt(3)
  s_waitcnt lgkmcnt(0)
  v_readfirstlane_b32 s7, v39
  s_nop 0
  s_cmp_eq_u32 s7, 0
  s_cbranch_scc1 L_fb_33
  s_waitcnt vmcnt(2)
L_fb_33:
  buffer_load_dwordx4 v[120:123], v1, s[12:15], s58 offen nt
  s_addk_i32 s58, 16384
  s_waitcnt vmcnt(3)
  s_cmp_eq_u32 s7, 0
  s_cbranch_scc1 L_fb_34
  s_waitcnt vmcnt(2)
L_fb_34:
  buffer_load_dwordx4 v[124:127], v1, s[12:15], s59 offen nt
  s_addk_i32 s59, 16384
  v_mov_b32 v38, 0
  v_mov_b32 v39, 54
  s_mov_b64 exec, 1
  ds_max_u32 v38, v39 offset:36
  s_mov_b64 exec, -1
  v_mov_b32 v38, 0
  ds_read_b32 v39, v38 offset:64
  s_waitcnt vmcnt(3)
  s_waitcnt lgkmcnt(0)
  v_readfirstlane_b32 s7, v39
  s_nop 0
  s_cmp_eq_u32 s7, 0
  s_cbranch_scc1 L_fb_35
  s_waitcnt vmcnt(2)
L_fb_35:
  buffer_load_dwordx4 v[128:131], v1, s[12:15], s58 offen nt
  s_addk_i32 s58, 16384
  s_waitcnt vmcnt(3)
  s_cmp_eq_u32 s7, 0
  s_cbranch_scc1 L_fb_36
  s_waitcnt vmcnt(2)
L_fb_36:
  buffer_load_dwordx4 v[132:135], v1, s[12:15], s59 offen nt
  s_addk_i32 s59, 16384
  v_mov_b32 v38, 0
  ds_read_b32 v39, v38 offset:64
  s_waitcnt vmcnt(3)
  s_waitcnt lgkmcnt(0)
  v_readfirstlane_b32 s7, v39
  s_nop 0
  s_cmp_eq_u32 s7, 0
  s_cbranch_scc1 L_fb_37
  s_waitcnt vmcnt(2)
L_fb_37:
  buffer_load_dwordx4 v[136:139], v1, s[12:15], s58 offen nt
  s_addk_i32 s58, 16384
  s_waitcnt vmcnt(3)
  s_cmp_eq_u32 s7, 0
  s_cbranch_scc1 L_fb_38
  s_waitcnt vmcnt(2)
L_fb_38:
  buffer_load_dwordx4 v[140:143], v1, s[12:15], s59 offen nt
  s_addk_i32 s59, 16384
  v_mov_b32 v38, 0
  v_mov_b32 v39, 58
  s_mov_b64 exec, 1
  ds_max_u32 v38, v39 offset:36
  s_mov_b64 exec, -1
  v_mov_b32 v38, 0
  ds_read_b32 v39, v38 offset:64
  s_waitcnt vmcnt(3)
  s_waitcnt lgkmcnt(0)
  v_readfirstlane_b32 s7, v39
  s_nop 0
  s_cmp_eq_u32 s7, 0
  s_cbranch_scc1 L_fb_39
  s_waitcnt vmcnt(2)
L_fb_39:
  buffer_load_dwordx4 v[144:147], v1, s[12:15], s58 offen nt
  s_addk_i32 s58, 16384
  s_waitcnt vmcnt(3)
  s_cmp_eq_u32 s7, 0
  s_cbranch_scc1 L_fb_40
  s_waitcnt vmcnt(2)
L_fb_40:
  buffer_load_dwordx4 v[148:151], v1, s[12:15], s59 offen nt
  s_addk_i32 s59, 16384
  v_mov_b32 v38, 0
  v_mov_b32 v39, 60
  s_mov_b64 exec, 1
  ds_max_u32 v38, v39 offset:36
  s_mov_b64 exec, -1
  v_mov_b32 v38, 0
  ds_read_b32 v39, v38 offset:64
  s_waitcnt vmcnt(3)
  s_waitcnt lgkmcnt(0)
  v_readfirstlane_b32 s7, v39
  s_nop 0
  s_cmp_eq_u32 s7, 0
  s_cbranch_scc1 L_fb_41
  s_waitcnt vmcnt(2)
L_fb_41:
  buffer_load_dwordx4 v[152:155], v1, s[12:15], s58 offen nt
  s_addk_i32 s58, 16384
  v_mov_b32 v38, 0
L_lw_42:
  ds_read_b32 v39, v38 offset:16
  s_waitcnt lgkmcnt(0)
  v_readfirstlane_b32 s53, v39
  s_nop 0
  s_cmp_eq_u32 s53, 1
  s_cbranch_scc1 L_lwd_43
  s_add_u32 s80, s80, 1
  s_cmp_gt_u32 s80, 4000000
  s_cbranch_scc1 L_exit
  s_sleep 1
  s_branch L_lw_42
L_lwd_43:
  ds_read_b128 v[14:17], v38 offset:96
  s_mov_b32 s54, 0x3fb8aa3b
  s_waitcnt lgkmcnt(0)
  v_sub_f32 v10, v10, v14
  v_mul_f32 v10, s54, v10
  v_exp_f32 v10, v10
  v_sub_f32 v11, v11, v16
  v_mul_f32 v11, s54, v11
  v_exp_f32 v11, v11
  v_sub_f32 v12, v12, v14
  v_mul_f32 v12, s54, v12
  v_exp_f32 v12, v12
  v_sub_f32 v13, v13, v16
  v_mul_f32 v13, s54, v13
  v_exp_f32 v13, v13
  v_mul_f32 v10, v10, v15
  v_mul_f32 v11, v11, v17
  v_cvt_pk_bf16_f32 v10, v10, v11
  v_mul_f32 v12, v12, v15
  v_mul_f32 v13, v13, v17
  v_cvt_pk_bf16_f32 v12, v12, v13
  v_and_b32 v13, 15, v0
  v_lshlrev_b32 v13, 5, v13
  v_bfe_u32 v11, v0, 4, 1
  v_lshl_add_u32 v13, v11, 4, v13
  v_lshrrev_b32 v11, 5, v0
  v_lshl_add_u32 v13, v11, 9, v13
  s_lshl_b32 s53, s3, 10
  v_add_u32 v13, s53, v13
  v_mov_b32 v20, 0
  v_mov_b32 v21, 1
  v_mov_b32_dpp v38, v10 row_newbcast:0 row_mask:0xf bank_mask:0xf
  v_perm_b32 v26, v38, v38, v22
  v_perm_b32 v27, v38, v38, v23
  v_perm_b32 v28, v38, v38, v24
  v_perm_b32 v29, v38, v38, v25
  v_mov_b32_dpp v39, v10 row_newbcast:8 row_mask:0xf bank_mask:0xf
  v_perm_b32 v30, v39, v39, v22
  v_perm_b32 v31, v39, v39, v23
  v_perm_b32 v32, v39, v39, v24
  v_perm_b32 v33, v39, v39, v25
  v_mfma_f32_16x16x32_bf16 v[34:37], v[26:29], v[40:43], 0
  v_mov_b32_dpp v38, v10 row_newbcast:4 row_mask:0xf bank_mask:0xf
  v_perm_b32 v26, v38, v38, v22
  v_perm_b32 v27, v38, v38, v23
  v_perm_b32 v28, v38, v38, v24
  v_perm_b32 v29, v38, v38, v25
  v_mfma_f32_16x16x32_bf16 v[34:37], v[30:33], v[44:47], v[34:37]
  v_mov_b32_dpp v39, v10 row_newbcast:12 row_mask:0xf bank_mask:0xf
  v_perm_b32 v30, v39, v39, v22
  v_perm_b32 v31, v39, v39, v23
  v_perm_b32 v32, v39, v39, v24
  v_perm_b32 v33, v39, v39, v25
  v_mfma_f32_16x16x32_bf16 v[34:37], v[26:29], v[48:51], v[34:37]
  v_mov_b32_dpp v38, v10 row_newbcast:2 row_mask:0xf bank_mask:0xf
  v_perm_b32 v26, v38, v38, v22
  v_perm_b32 v27, v38, v38, v23
  v_perm_b32 v28, v38, v38, v24
  v_perm_b32 v29, v38, v38, v25
  v_mfma_f32_16x16x32_bf16 v[34:37], v[30:33], v[52:55], v[34:37]
  v_mov_b32_dpp v39, v10 row_newbcast:10 row_mask:0xf bank_mask:0xf
  v_perm_b32 v30, v39, v39, v22
  v_perm_b32 v31, v39, v39, v23
  v_perm_b32 v32, v39, v39, v24
  v_perm_b32 v33, v39, v39, v25
  v_mfma_f32_16x16x32_bf16 v[34:37], v[26:29], v[56:59], v[34:37]
  v_mov_b32_dpp v38, v10 row_newbcast:6 row_mask:0xf bank_mask:0xf
  v_perm_b32 v26, v38, v38, v22
  v_perm_b32 v27, v38, v38, v23
  v_perm_b32 v28, v38, v38, v24
  v_perm_b32 v29, v38, v38, v25
  v_mfma_f32_16x16x32_bf16 v[34:37], v[30:33], v[60:63], v[34:37]
  s_waitcnt vmcnt(3)
  s_cmp_eq_u32 s7, 0
  s_cbranch_scc1 L_fb_44
  s_waitcnt vmcnt(2)
L_fb_44:
  buffer_load_dwordx4 v[156:159], v1, s[12:15], s59 offen nt
  s_addk_i32 s59, 16384
  v_mov_b32_dpp v39, v10 row_newbcast:14 row_mask:0xf bank_mask:0xf
  v_perm_b32 v30, v39, v39, v22
  v_perm_b32 v31, v39, v39, v23
  v_perm_b32 v32, v39, v39, v24
  v_perm_b32 v33, v39, v39, v25
  v_mfma_f32_16x16x32_bf16 v[34:37], v[26:29], v[64:67], v[34:37]
  v_mov_b32_dpp v38, v10 row_newbcast:1 row_mask:0xf bank_mask:0xf
  v_perm_b32 v26, v38, v38, v22
  v_perm_b32 v27, v38, v38, v23
  v_perm_b32 v28, v38, v38, v24
  v_perm_b32 v29, v38, v38, v25
  v_mfma_f32_16x16x32_bf16 v[34:37], v[30:33], v[68:71], v[34:37]
  v_mov_b32_dpp v39, v10 row_newbcast:9 row_mask:0xf bank_mask:0xf
  v_perm_b32 v30, v39, v39, v22
  v_perm_b32 v31, v39, v39, v23
  v_perm_b32 v32, v39, v39, v24
  v_perm_b32 v33, v39, v39, v25
  v_mfma_f32_16x16x32_bf16 v[34:37], v[26:29], v[72:75], v[34:37]
  v_mov_b32_dpp v38, v10 row_newbcast:5 row_mask:0xf bank_mask:0xf
  v_perm_b32 v26, v38, v38, v22
  v_perm_b32 v27, v38, v38, v23
  v_perm_b32 v28, v38, v38, v24
  v_perm_b32 v29, v38, v38, v25
  v_mfma_f32_16x16x32_bf16 v[34:37], v[30:33], v[76:79], v[34:37]
  v_mov_b32_dpp v39, v10 row_newbcast:13 row_mask:0xf bank_mask:0xf
  v_perm_b32 v30, v39, v39, v22
  v_perm_b32 v31, v39, v39, v23
  v_perm_b32 v32, v39, v39, v24
  v_perm_b32 v33, v39, v39, v25
  v_mfma_f32_16x16x32_bf16 v[34:37], v[26:29], v[80:83], v[34:37]
  v_mov_b32_dpp v38, v10 row_newbcast:3 row_mask:0xf bank_mask:0xf
  v_perm_b32 v26, v38, v38, v22
  v_perm_b32 v27, v38, v38, v23
  v_perm_b32 v28, v38, v38, v24
  v_perm_b32 v29, v38, v38, v25
  v_mfma_f32_16x16x32_bf16 v[34:37], v[30:33], v[84:87], v[34:37]
  v_mov_b32 v38, 0
  ds_read_b32 v39, v38 offset:64
  s_waitcnt vmcnt(3)
  s_waitcnt lgkmcnt(0)
  v_readfirstlane_b32 s7, v39
  s_nop 0
  s_cmp_eq_u32 s7, 0
  s_cbranch_scc1 L_fb_45
  s_waitcnt vmcnt(2)
L_fb_45:
  buffer_load_dwordx4 v[160:163], v1, s[12:15], s58 offen nt
  s_addk_i32 s58, 16384
  v_mov_b32_dpp v39, v10 row_newbcast:11 row_mask:0xf bank_mask:0xf
  v_perm_b32 v30, v39, v39, v22
  v_perm_b32 v31, v39, v39, v23
  v_perm_b32 v32, v39, v39, v24
  v_perm_b32 v33, v39, v39, v25
  v_mfma_f32_16x16x32_bf16 v[34:37], v[26:29], v[88:91], v[34:37]
  v_mov_b32_dpp v38, v10 row_newbcast:7 row_mask:0xf bank_mask:0xf
  v_perm_b32 v26, v38, v38, v22
  v_perm_b32 v27, v38, v38, v23
  v_perm_b32 v28, v38, v38, v24
  v_perm_b32 v29, v38, v38, v25
  v_mfma_f32_16x16x32_bf16 v[34:37], v[30:33], v[92:95], v[34:37]
  v_mov_b32_dpp v39, v10 row_newbcast:15 row_mask:0xf bank_mask:0xf
  v_perm_b32 v30, v39, v39, v22
  v_perm_b32 v31, v39, v39, v23
  v_perm_b32 v32, v39, v39, v24
  v_perm_b32 v33, v39, v39, v25
  v_mfma_f32_16x16x32_bf16 v[34:37], v[26:29], v[96:99], v[34:37]
  v_mov_b32_dpp v38, v12 row_newbcast:0 row_mask:0xf bank_mask:0xf
  v_perm_b32 v26, v38, v38, v22
  v_perm_b32 v27, v38, v38, v23
  v_perm_b32 v28, v38, v38, v24
  v_perm_b32 v29, v38, v38, v25
  v_mfma_f32_16x16x32_bf16 v[34:37], v[30:33], v[100:103], v[34:37]
  v_mov_b32_dpp v39, v12 row_newbcast:8 row_mask:0xf bank_mask:0xf
  v_perm_b32 v30, v39, v39, v22
  v_perm_b32 v31, v39, v39, v23
  v_perm_b32 v32, v39, v39, v24
  v_perm_b32 v33, v39, v39, v25
  v_mfma_f32_16x16x32_bf16 v[34:37], v[26:29], v[104:107], v[34:37]
  v_mov_b32_dpp v38, v12 row_newbcast:4 row_mask:0xf bank_mask:0xf
  v_perm_b32 v26, v38, v38, v22
  v_perm_b32 v27, v38, v38, v23
  v_perm_b32 v28, v38, v38, v24
  v_perm_b32 v29, v38, v38, v25
  v_mfma_f32_16x16x32_bf16 v[34:37], v[30:33], v[108:111], v[34:37]
  s_waitcnt vmcnt(3)
  s_cmp_eq_u32 s7, 0
  s_cbranch_scc1 L_fb_46
  s_waitcnt vmcnt(2)
L_fb_46:
  buffer_load_dwordx4 v[164:167], v1, s[12:15], s59 offen nt
  s_addk_i32 s59, 16384
  v_mov_b32 v38, 0
  v_mov_b32 v39, 1
  s_mov_b64 exec, 1
  ds_add_u32 v38, v39 offset:28
  s_mov_b64 exec, -1
  v_mov_b32_dpp v39, v12 row_newbcast:12 row_mask:0xf bank_mask:0xf
  v_perm_b32 v30, v39, v39, v22
  v_perm_b32 v31, v39, v39, v23
  v_perm_b32 v32, v39, v39, v24
  v_perm_b32 v33, v39, v39, v25
  v_mfma_f32_16x16x32_bf16 v[34:37], v[26:29], v[112:115], v[34:37]
  v_mov_b32_dpp v38, v12 row_newbcast:2 row_mask:0xf bank_mask:0xf
  v_perm_b32 v26, v38, v38, v22
  v_perm_b32 v27, v38, v38, v23
  v_perm_b32 v28, v38, v38, v24
  v_perm_b32 v29, v38, v38, v25
  v_mfma_f32_16x16x32_bf16 v[34:37], v[30:33], v[116:119], v[34:37]
  v_mov_b32_dpp v39, v12 row_newbcast:10 row_mask:0xf bank_mask:0xf
  v_perm_b32 v30, v39, v39, v22
  v_perm_b32 v31, v39, v39, v23
  v_perm_b32 v32, v39, v39, v24
  v_perm_b32 v33, v39, v39, v25
  v_mfma_f32_16x16x32_bf16 v[34:37], v[26:29], v[120:123], v[34:37]
  v_mov_b32_dpp v38, v12 row_newbcast:6 row_mask:0xf bank_mask:0xf
  v_perm_b32 v26, v38, v38, v22
  v_perm_b32 v27, v38, v38, v23
  v_perm_b32 v28, v38, v38, v24
  v_perm_b32 v29, v38, v38, v25
  v_mfma_f32_16x16x32_bf16 v[34:37], v[30:33], v[124:127], v[34:37]
  v_mov_b32_dpp v39, v12 row_newbcast:14 row_mask:0xf bank_mask:0xf
  v_perm_b32 v30, v39, v39, v22
  v_perm_b32 v31, v39, v39, v23
  v_perm_b32 v32, v39, v39, v24
  v_perm_b32 v33, v39, v39, v25
  v_mfma_f32_16x16x32_bf16 v[34:37], v[26:29], v[128:131], v[34:37]
  v_mov_b32_dpp v38, v12 row_newbcast:1 row_mask:0xf bank_mask:0xf
  v_perm_b32 v26, v38, v38, v22
  v_perm_b32 v27, v38, v38, v23
  v_perm_b32 v28, v38, v38, v24
  v_perm_b32 v29, v38, v38, v25
  v_mfma_f32_16x16x32_bf16 v[34:37], v[30:33], v[132:135], v[34:37]
  v_mov_b32_dpp v39, v12 row_newbcast:9 row_mask:0xf bank_mask:0xf
  v_perm_b32 v30, v39, v39, v22
  v_perm_b32 v31, v39, v39, v23
  v_perm_b32 v32, v39, v39, v24
  v_perm_b32 v33, v39, v39, v25
  v_mfma_f32_16x16x32_bf16 v[34:37], v[26:29], v[136:139], v[34:37]
  v_mov_b32_dpp v38, v12 row_newbcast:5 row_mask:0xf bank_mask:0xf
  v_perm_b32 v26, v38, v38, v22
  v_perm_b32 v27, v38, v38, v23
  v_perm_b32 v28, v38, v38, v24
  v_perm_b32 v29, v38, v38, v25
  v_mfma_f32_16x16x32_bf16 v[34:37], v[30:33], v[140:143], v[34:37]
  v_mov_b32_dpp v39, v12 row_newbcast:13 row_mask:0xf bank_mask:0xf
  v_perm_b32 v30, v39, v39, v22
  v_perm_b32 v31, v39, v39, v23
  v_perm_b32 v32, v39, v39, v24
  v_perm_b32 v33, v39, v39, v25
  v_mfma_f32_16x16x32_bf16 v[34:37], v[26:29], v[144:147], v[34:37]
  v_mov_b32_dpp v38, v12 row_newbcast:3 row_mask:0xf bank_mask:0xf
  v_perm_b32 v26, v38, v38, v22
  v_perm_b32 v27, v38, v38, v23
  v_perm_b32 v28, v38, v38, v24
  v_perm_b32 v29, v38, v38, v25
  v_mfma_f32_16x16x32_bf16 v[34:37], v[30:33], v[148:151], v[34:37]
  v_mov_b32_dpp v39, v12 row_newbcast:11 row_mask:0xf bank_mask:0xf
  v_perm_b32 v30, v39, v39, v22
  v_perm_b32 v31, v39, v39, v23
  v_perm_b32 v32, v39, v39, v24
  v_perm_b32 v33, v39, v39, v25
  s_waitcnt vmcnt(3)
  v_mfma_f32_16x16x32_bf16 v[34:37], v[26:29], v[152:155], v[34:37]
  v_mov_b32_dpp v38, v12 row_newbcast:7 row_mask:0xf bank_mask:0xf
  v_perm_b32 v26, v38, v38, v22
  v_perm_b32 v27, v38, v38, v23
  v_perm_b32 v28, v38, v38, v24
  v_perm_b32 v29, v38, v38, v25
  s_waitcnt vmcnt(2)
  v_mfma_f32_16x16x32_bf16 v[34:37], v[30:33], v[156:159], v[34:37]
  v_mov_b32_dpp v39, v12 row_newbcast:15 row_mask:0xf bank_mask:0xf
  v_perm_b32 v30, v39, v39, v22
  v_perm_b32 v31, v39, v39, v23
  v_perm_b32 v32, v39, v39, v24
  v_perm_b32 v33, v39, v39, v25
  s_waitcnt vmcnt(1)
  v_mfma_f32_16x16x32_bf16 v[34:37], v[26:29], v[160:163], v[34:37]
  s_waitcnt vmcnt(0)
  v_mfma_f32_16x16x32_bf16 v[34:37], v[30:33], v[164:167], v[34:37]
  s_nop 7
  ds_write_b128 v13, v[34:37] offset:8192
  s_mov_b64 exec, 1
  ds_add_u32 v20, v21 offset:20
  s_mov_b64 exec, -1
  s_cmp_lt_u32 s5, 9
  s_cbranch_scc1 L_tail_wo
L_tail:
  s_lshl_b32 s54, s3, 8
  s_add_u32 s54, s54, 5632
  s_movk_i32 s55, 5632
  v_and_b32 v12, 31, v0
  v_lshrrev_b32 v13, 5, v0
  v_lshlrev_b32 v1, 4, v12
  v_mul_u32_u24 v2, 1152, v13
  v_lshl_add_u32 v2, v12, 2, v2
  v_mul_u32_u24 v3, 0x0202, v13
  v_lshlrev_b32 v3, 16, v3
  v_add_u32 v3, 0x01000c0c, v3
  v_and_b32 v14, 1, v0
  v_lshlrev_b32 v5, 6, v14
  v_lshrrev_b32 v14, 4, v0
  v_lshl_add_u32 v5, v14, 4, v5
  v_add_u32 v5, s55, v5
  v_lshlrev_b32 v10, 3, v0
  v_lshrrev_b32 v14, 5, v0
  v_mul_u32_u24 v4, 64, v14
  v_lshrrev_b32 v14, 4, v12
  v_mul_u32_u24 v14, 128, v14
  v_add_u32 v4, v14, v4
  v_bfe_u32 v14, v12, 1, 2
  v_lshl_add_u32 v4, v14, 4, v4
  v_bfe_u32 v14, v12, 3, 1
  v_lshl_add_u32 v4, v14, 3, v4
  v_and_b32 v14, 1, v12
  v_lshl_add_u32 v4, v14, 2, v4
  v_add_u32 v4, s54, v4
  v_mov_b32 v14, 0
L_lw_47:
  ds_read_b32 v15, v14 offset:4
  s_waitcnt lgkmcnt(0)
  v_readfirstlane_b32 s53, v15
  s_nop 0
  s_cmp_eq_u32 s53, 1
  s_cbranch_scc1 L_lwd_48
  s_add_u32 s80, s80, 1
  s_cmp_gt_u32 s80, 4000000
  s_cbranch_scc1 L_exit
  s_sleep 1
  s_branch L_lw_47
L_lwd_48:
  ds_read_b32 v15, v14 offset:0
  s_waitcnt lgkmcnt(0)
  v_readfirstlane_b32 s52, v15
  s_nop 0
  s_and_b32 s87, s52, 0xff
  s_mul_i32 s88, s87, 0x01010101
  s_xor_b32 s88, s88, 0xe19c3500
  v_mov_b32 v11, s88
  s_mov_b32 s89, 0
  s_mov_b32 s26, 0x7060500
  s_bfe_u32 s30, s88, 0x80000
  s_mov_b32 s27, 0x7060501
  s_bfe_u32 s31, s88, 0x80008
  s_mov_b32 s28, 0x7060502
  s_bfe_u32 s32, s88, 0x80010
  s_mov_b32 s29, 0x7060503
  s_bfe_u32 s33, s88, 0x80018
  s_mov_b32 s20, s24
  s_mov_b32 s21, s25
  s_mov_b32 s22, 2304
  s_mov_b32 s23, 0x20000
  s_cmp_lt_u32 s5, 27
  s_cbranch_scc1 L_tail_ffn
  s_mul_i32 s82, s4, 5
  s_add_u32 s82, s82, s5
  s_sub_u32 s82, s82, 27
  s_cmp_lt_u32 s82, 36
  s_cbranch_scc0 L_exit
  v_mov_b32 v14, 0
L_lw_49:
  ds_read_b32 v15, v14 offset:24
  s_waitcnt lgkmcnt(0)
  v_readfirstlane_b32 s53, v15
  s_nop 0
  s_cmp_eq_u32 s53, 3
  s_cbranch_scc1 L_lwd_50
  s_add_u32 s80, s80, 1
  s_cmp_gt_u32 s80, 4000000
  s_cbranch_scc1 L_exit
  s_sleep 1
  s_branch L_lw_49
L_lwd_50:
  s_cmp_eq_u32 s3, 9
  s_cbranch_scc1 L_red_x1
  s_mul_i32 s53, s82, 18560
  s_lshl_b32 s54, s3, 11
  s_add_u32 s53, s53, s54
  s_add_u32 s60, s53, 458752
  v_lshlrev_b32 v18, 4, v0
  v_lshlrev_b32 v12, 2, v0
  s_lshl_b32 s54, s3, 8
  v_add_u32 v13, s54, v12
  v_add_u32 v12, 2560, v12
  v_and_b32 v14, 0x17, v0
  s_bfe_u32 s54, s82, 0x10001
  s_lshl_b32 s54, s54, 5
  s_and_b32 s55, s82, 1
  s_lshl_b32 s55, s55, 3
  s_add_u32 s54, s54, s55
  v_add_u32 v14, s54, v14
  v_lshrrev_b32 v15, 5, v0
  v_lshl_add_u32 v16, v15, 6, v14
  v_lshlrev_b32 v16, 3, v16
  v_mul_u32_u24 v17, 576, v15
  v_add_u32 v17, v17, v14
  s_lshr_b32 s54, s82, 2
  s_lshl_b32 s54, s54, 6
  v_add_u32 v17, s54, v17
  v_lshlrev_b32 v17, 1, v17
  v_mov_b32 v32, 0
  v_mov_b32 v33, 1
  s_mov_b32 s20, s46
  s_mov_b32 s21, s47
  s_mov_b32 s22, 2304
  s_mov_b32 s23, 0x20000
  v_mov_b32 v14, 0
L_lw_51:
  ds_read_b32 v15, v14 offset:48
  s_waitcnt lgkmcnt(0)
  v_readfirstlane_b32 s53, v15
  s_nop 0
  s_cmp_eq_u32 s53, 1
  s_cbranch_scc1 L_lwd_52
  s_add_u32 s80, s80, 1
  s_cmp_gt_u32 s80, 4000000
  s_cbranch_scc1 L_exit
  s_sleep 2
  s_branch L_lw_51
L_lwd_52:
  buffer_load_dwordx4 v[20:23], v18, s[16:19], s60 offen offset:0 sc1
  buffer_load_dwordx4 v[24:27], v18, s[16:19], s60 offen offset:1024 sc1
  s_mov_b64 s[64:65], -1
  s_mov_b64 s[66:67], -1
  s_branch L_polle_55
L_poll_53:
  s_mov_b64 exec, s[64:65]
  buffer_load_dwordx4 v[20:23], v18, s[16:19], s60 offen offset:0 sc1
  s_mov_b64 exec, s[66:67]
  buffer_load_dwordx4 v[24:27], v18, s[16:19], s60 offen offset:1024 sc1
  s_mov_b64 exec, -1
  s_add_u32 s80, s80, 1
  s_cmp_gt_u32 s80, 4000000
  s_cbranch_scc1 L_exit
L_polle_55:
  s_mov_b64 exec, s[64:65]
  s_cbranch_execz L_sk_56
  s_waitcnt vmcnt(1)
  v_xor_b32 v20, s30, v20
  v_xor_b32 v21, s31, v21
  v_xor_b32 v22, s32, v22
  v_xor_b32 v23, s33, v23
  v_or3_b32 v14, v20, v21, v22
  v_or_b32 v14, v14, v23
  v_cmp_ne_u32_sdwa s[64:65], v14, s89 src0_sel:BYTE_0 src1_sel:DWORD
  s_nop 0
  s_wqm_b64 s[64:65], s[64:65]
L_sk_56:
  s_mov_b64 exec, s[66:67]
  s_cbranch_execz L_sk_57
  s_waitcnt vmcnt(0)
  v_xor_b32 v24, s30, v24
  v_xor_b32 v25, s31, v25
  v_xor_b32 v26, s32, v26
  v_xor_b32 v27, s33, v27
  v_or3_b32 v14, v24, v25, v26
  v_or_b32 v14, v14, v27
  v_cmp_ne_u32_sdwa s[66:67], v14, s89 src0_sel:BYTE_0 src1_sel:DWORD
  s_nop 0
  s_wqm_b64 s[66:67], s[66:67]
L_sk_57:
  s_mov_b64 exec, -1
  s_or_b64 s[54:55], s[64:65], s[66:67]
  s_cbranch_scc1 L_poll_53
  v_pk_add_f32 v[20:21], v[20:21], v[24:25]
  v_pk_add_f32 v[22:23], v[22:23], v[26:27]
  s_nop 0
  v_permlane32_swap_b32 v20, v21
  v_permlane32_swap_b32 v22, v23
  v_add_f32 v20, v20, v21
  v_add_f32 v22, v22, v23
  s_nop 1
  v_permlane16_swap_b32 v20, v22
  v_add_f32 v20, v20, v22
  s_nop 1
  v_add_f32_dpp v20, v20, v20 row_ror:8 row_mask:0xf bank_mask:0xf
  ds_write_b32 v13, v20 offset:2560
  s_waitcnt lgkmcnt(0)
  s_barrier
  s_cmp_lg_u32 s3, 0
  s_cbranch_scc1 L_exit
  ds_read2st64_b32 v[20:21], v12 offset0:0 offset1:1
  ds_read2st64_b32 v[22:23], v12 offset0:2 offset1:3
  ds_read2st64_b32 v[24:25], v12 offset0:4 offset1:5
  ds_read2st64_b32 v[26:27], v12 offset0:6 offset1:7
  ds_read_b32 v28, v12 offset:2048
  ds_read_b64 v[30:31], v16 offset:1280
  s_mov_b32 exec_lo, 0x00ff00ff
  s_mov_b32 exec_hi, 0x00ff00ff
  s_waitcnt lgkmcnt(4)
  v_add_f32 v20, v20, v21
  v_add_f32 v22, v22, v23
  s_waitcnt lgkmcnt(2)
  v_add_f32 v24, v24, v25
  v_add_f32 v26, v26, v27
  v_add_f32 v20, v20, v22
  s_waitcnt lgkmcnt(0)
  v_add_f32 v24, v24, v26
  v_add_f32 v20, v20, v28
  v_add_f32 v20, v20, v24
  v_cvt_pk_bf16_f32 v20, v20, v20
  v_lshlrev_b32 v20, 16, v20
  v_mul_f32 v20, v20, v31
  v_cvt_pk_bf16_f32 v20, v20, v20
  v_lshlrev_b32 v20, 16, v20
  v_add_f32 v20, v20, v30
  v_cvt_pk_bf16_f32 v20, v20, v20
  buffer_store_short v20, v17, s[20:23], 0 offen
  s_mov_b64 exec, -1
  s_branch L_exit
  s_cmp_lg_u32 s82, 0
  s_cbranch_scc1 L_exit
  v_mov_b32 v15, s52
  s_mov_b64 exec, 1
  buffer_store_dword v15, off, s[16:19], 0 offset:0 sc1
  s_mov_b64 exec, -1
  s_branch L_exit
L_red_x1:
  s_lshr_b32 s83, s82, 2
  s_lshl_b32 s60, s83, 9
  s_add_u32 s60, s60, 27136
  buffer_load_dwordx4 v[24:27], v1, s[16:19], s60 offen sc1
  s_branch L_polle_60
L_poll_58:
  s_mov_b64 exec, s[64:65]
  buffer_load_dwordx4 v[24:27], v1, s[16:19], s60 offen sc1
  s_mov_b64 exec, -1
  s_add_u32 s80, s80, 1
  s_cmp_gt_u32 s80, 4000000
  s_cbranch_scc1 L_exit
L_polle_60:
  s_waitcnt vmcnt(0)
  v_xor_b32 v14, s52, v25
  v_xor_b32 v15, s52, v27
  v_or_b32 v14, v14, v15
  v_cmp_ne_u32 s[64:65], 0, v14
  s_nop 0
  s_cmp_lg_u64 s[64:65], 0
  s_cbranch_scc0 L_polld_59
  s_sleep 2
  s_branch L_poll_58
L_polld_59:
  v_perm_b32 v24, v24, v24, v3
  v_perm_b32 v25, v26, v26, v3
  s_mul_i32 s60, s4, 5120
  s_lshl_b32 s53, s83, 9
  s_add_u32 s60, s60, s53
  s_add_u32 s60, s60, 1130496
  buffer_load_dwordx2 v[40:41], v10, s[16:19], s60 offen sc1
  s_branch L_polle_63
L_poll_61:
  s_mov_b64 exec, s[64:65]
  buffer_load_dwordx2 v[40:41], v10, s[16:19], s60 offen sc1
  s_mov_b64 exec, -1
  s_add_u32 s80, s80, 1
  s_cmp_gt_u32 s80, 4000000
  s_cbranch_scc1 L_exit
L_polle_63:
  s_waitcnt vmcnt(0)
  v_cmp_ne_u32 s[64:65], s52, v41
  s_nop 0
  s_wqm_b64 s[64:65], s[64:65]
  s_cmp_lg_u64 s[64:65], 0
  s_cbranch_scc0 L_polld_62
  s_sleep 4
  s_branch L_poll_61
L_polld_62:
  v_and_b32 v42, 0xffff0000, v40
  v_lshlrev_b32 v40, 16, v40
  v_mov_b32 v41, v24
  v_mov_b32 v43, v25
  v_lshlrev_b32 v18, 4, v0
  ds_write_b128 v18, v[40:43] offset:1280
  v_mov_b32 v14, 0
  v_mov_b32 v15, 1
  s_mov_b64 exec, 1
  ds_add_u32 v14, v15 offset:48
  s_mov_b64 exec, -1
  s_cmp_lg_u32 s82, 0
  s_cbranch_scc1 L_nep
  v_mov_b32 v15, s52
  s_mov_b64 exec, 1
  buffer_store_dword v15, off, s[16:19], 0 offset:0 sc1
  s_mov_b64 exec, -1
L_nep:
  s_waitcnt lgkmcnt(0)
  s_barrier
  s_branch L_exit
L_tail_wo:
  v_mov_b32 v14, 0
L_lw_64:
  ds_read_b32 v15, v14 offset:48
  s_waitcnt lgkmcnt(0)
  v_readfirstlane_b32 s53, v15
  s_nop 0
  s_cmp_eq_u32 s53, 1
  s_cbranch_scc1 L_lwd_65
  s_add_u32 s80, s80, 1
  s_cmp_gt_u32 s80, 4000000
  s_cbranch_scc1 L_exit
  s_sleep 1
  s_branch L_lw_64
L_lwd_65:
  buffer_load_dwordx4 v[40:43], v2, s[16:19], s62 offen offset:0 sc1
  buffer_load_dwordx4 v[44:47], v2, s[16:19], s62 offen offset:2048 sc1
  buffer_load_dwordx4 v[48:51], v2, s[16:19], s63 offen offset:0 sc1
  buffer_load_dwordx4 v[52:55], v2, s[16:19], s63 offen offset:2048 sc1
  s_mov_b64 s[64:65], -1
  s_mov_b64 s[66:67], -1
  s_mov_b64 s[68:69], -1
  s_mov_b64 s[70:71], -1
  v_and_b32 v18, 1, v0
  v_lshlrev_b32 v18, 4, v18
  v_lshrrev_b32 v11, v18, v3
  v_and_b32 v18, 15, v0
  v_bfe_u32 v19, v0, 4, 1
  v_lshl_add_u32 v12, v18, 1, v19
  v_lshlrev_b32 v17, 3, v18
  s_lshl_b32 s60, s5, 12
  s_lshl_b32 s53, s4, 9
  s_add_u32 s60, s60, s53
  s_lshl_b32 s53, s3, 7
  s_add_u32 s60, s60, s53
  s_add_u32 s60, s60, 393216
  s_lshl_b32 s54, s3, 8
  s_add_u32 s54, s54, 5632
  v_lshrrev_b32 v14, 5, v0
  v_mul_u32_u24 v4, 64, v14
  v_lshrrev_b32 v14, 4, v12
  v_mul_u32_u24 v14, 128, v14
  v_add_u32 v4, v14, v4
  v_bfe_u32 v14, v12, 1, 2
  v_lshl_add_u32 v4, v14, 4, v4
  v_bfe_u32 v14, v12, 3, 1
  v_lshl_add_u32 v4, v14, 3, v4
  v_and_b32 v14, 1, v12
  v_lshl_add_u32 v4, v14, 2, v4
  v_add_u32 v4, s54, v4
  s_cmp_ge_u32 s3, 4
  s_cbranch_scc1 L_wo_nf
  s_lshl_b32 s54, s3, 1
  v_bfe_u32 v14, v0, 1, 1
  v_mul_u32_u24 v14, 1, v14
  v_add_u32 v14, s54, v14
  v_bfe_u32 v15, v0, 3, 2
  v_lshlrev_b32 v15, 1, v15
  v_xor_b32 v14, v14, v15
  v_lshrrev_b32 v6, 2, v0
  v_lshlrev_b32 v6, 7, v6
  v_lshl_add_u32 v6, v14, 4, v6
  v_and_b32 v14, 1, v0
  v_lshl_add_u32 v6, v14, 3, v6
  v_add_u32 v6, 16384, v6
  v_add_u32 v7, 36864, v6
  ds_read_b64_tr_b16 v[96:97], v6 offset:0
  ds_read_b64_tr_b16 v[98:99], v6 offset:2048
  ds_read_b64_tr_b16 v[100:101], v6 offset:4096
  ds_read_b64_tr_b16 v[102:103], v6 offset:6144
  ds_read_b64_tr_b16 v[104:105], v6 offset:8192
  ds_read_b64_tr_b16 v[106:107], v6 offset:10240
  ds_read_b64_tr_b16 v[108:109], v6 offset:12288
  ds_read_b64_tr_b16 v[110:111], v6 offset:14336
  ds_read_b64_tr_b16 v[112:113], v6 offset:16384
  ds_read_b64_tr_b16 v[114:115], v6 offset:18432
  ds_read_b64_tr_b16 v[116:117], v6 offset:20480
  ds_read_b64_tr_b16 v[118:119], v6 offset:22528
  ds_read_b64_tr_b16 v[120:121], v6 offset:24576
  ds_read_b64_tr_b16 v[122:123], v6 offset:26624
  ds_read_b64_tr_b16 v[124:125], v6 offset:28672
  ds_read_b64_tr_b16 v[126:127], v6 offset:30720
  ds_read_b64_tr_b16 v[128:129], v6 offset:32768
  ds_read_b64_tr_b16 v[130:131], v6 offset:34816
  ds_read_b64_tr_b16 v[132:133], v7 offset:0
  ds_read_b64_tr_b16 v[134:135], v7 offset:2048
  ds_read_b64_tr_b16 v[136:137], v7 offset:4096
  ds_read_b64_tr_b16 v[138:139], v7 offset:6144
  ds_read_b64_tr_b16 v[140:141], v7 offset:8192
  ds_read_b64_tr_b16 v[142:143], v7 offset:10240
  ds_read_b64_tr_b16 v[144:145], v7 offset:12288
  ds_read_b64_tr_b16 v[146:147], v7 offset:14336
  ds_read_b64_tr_b16 v[148:149], v7 offset:16384
  ds_read_b64_tr_b16 v[150:151], v7 offset:18432
  ds_read_b64_tr_b16 v[152:153], v7 offset:20480
  ds_read_b64_tr_b16 v[154:155], v7 offset:22528
  ds_read_b64_tr_b16 v[156:157], v7 offset:24576
  ds_read_b64_tr_b16 v[158:159], v7 offset:26624
  v_and_b32 v14, 1, v0
  v_lshlrev_b32 v5, 6, v14
  v_lshrrev_b32 v14, 4, v0
  v_lshl_add_u32 v5, v14, 4, v5
  v_bfe_u32 v14, v0, 3, 1
  v_lshl_add_u32 v5, v14, 7, v5
  v_add_u32 v5, 5632, v5
L_wo_nf:
  s_branch L_polle_68
L_poll_66:
  s_mov_b64 exec, s[64:65]
  buffer_load_dwordx4 v[40:43], v2, s[16:19], s62 offen offset:0 sc1
  s_mov_b64 exec, s[66:67]
  buffer_load_dwordx4 v[44:47], v2, s[16:19], s62 offen offset:2048 sc1
  s_mov_b64 exec, s[68:69]
  buffer_load_dwordx4 v[48:51], v2, s[16:19], s63 offen offset:0 sc1
  s_mov_b64 exec, s[70:71]
  buffer_load_dwordx4 v[52:55], v2, s[16:19], s63 offen offset:2048 sc1
  s_mov_b64 exec, -1
  s_add_u32 s80, s80, 1
  s_cmp_gt_u32 s80, 4000000
  s_cbranch_scc1 L_exit
L_polle_68:
  s_mov_b64 exec, s[64:65]
  s_cbranch_execz L_sk_69
  s_waitcnt vmcnt(3)
  v_xor_b32 v40, s30, v40
  v_xor_b32 v41, s31, v41
  v_xor_b32 v42, s32, v42
  v_xor_b32 v43, s33, v43
  v_or3_b32 v14, v40, v41, v42
  v_or_b32 v14, v14, v43
  v_cmp_ne_u32_sdwa s[64:65], v14, s89 src0_sel:BYTE_0 src1_sel:DWORD
  s_nop 0
  s_wqm_b64 s[64:65], s[64:65]
L_sk_69:
  s_mov_b64 exec, s[66:67]
  s_cbranch_execz L_sk_70
  s_waitcnt vmcnt(2)
  v_xor_b32 v44, s30, v44
  v_xor_b32 v45, s31, v45
  v_xor_b32 v46, s32, v46
  v_xor_b32 v47, s33, v47
  v_or3_b32 v14, v44, v45, v46
  v_or_b32 v14, v14, v47
  v_cmp_ne_u32_sdwa s[66:67], v14, s89 src0_sel:BYTE_0 src1_sel:DWORD
  s_nop 0
  s_wqm_b64 s[66:67], s[66:67]
L_sk_70:
  s_mov_b64 exec, s[68:69]
  s_cbranch_execz L_sk_71
  s_waitcnt vmcnt(1)
  v_xor_b32 v48, s30, v48
  v_xor_b32 v49, s31, v49
  v_xor_b32 v50, s32, v50
  v_xor_b32 v51, s33, v51
  v_or3_b32 v14, v48, v49, v50
  v_or_b32 v14, v14, v51
  v_cmp_ne_u32_sdwa s[68:69], v14, s89 src0_sel:BYTE_0 src1_sel:DWORD
  s_nop 0
  s_wqm_b64 s[68:69], s[68:69]
L_sk_71:
  s_mov_b64 exec, s[70:71]
  s_cbranch_execz L_sk_72
  s_waitcnt vmcnt(0)
  v_xor_b32 v52, s30, v52
  v_xor_b32 v53, s31, v53
  v_xor_b32 v54, s32, v54
  v_xor_b32 v55, s33, v55
  v_or3_b32 v14, v52, v53, v54
  v_or_b32 v14, v14, v55
  v_cmp_ne_u32_sdwa s[70:71], v14, s89 src0_sel:BYTE_0 src1_sel:DWORD
  s_nop 0
  s_wqm_b64 s[70:71], s[70:71]
L_sk_72:
  s_mov_b64 exec, -1
  s_or_b64 s[54:55], s[64:65], s[66:67]
  s_or_b64 s[54:55], s[54:55], s[68:69]
  s_or_b64 s[54:55], s[54:55], s[70:71]
  s_cbranch_scc1 L_poll_66
  v_pk_add_f32 v[40:41], v[40:41], v[44:45]
  v_pk_add_f32 v[42:43], v[42:43], v[46:47]
  v_pk_add_f32 v[48:49], v[48:49], v[52:53]
  v_pk_add_f32 v[50:51], v[50:51], v[54:55]
  v_pk_add_f32 v[40:41], v[40:41], v[48:49]
  v_pk_add_f32 v[42:43], v[42:43], v[50:51]
  s_nop 1
  v_permlane16_swap_b32 v40, v42
  v_permlane16_swap_b32 v41, v43
  v_pk_add_f32 v[40:41], v[40:41], v[42:43]
  v_cvt_pk_bf16_f32 v40, v40, v41
  ds_write_b32 v4, v40
  s_waitcnt lgkmcnt(0)
  s_barrier
  s_cmp_ge_u32 s3, 4
  s_cbranch_scc1 L_exit
  ds_read_b128 v[56:59], v5 offset:0
  ds_read_b128 v[60:63], v5 offset:256
  ds_read_b128 v[64:67], v5 offset:512
  ds_read_b128 v[68:71], v5 offset:768
  ds_read_b128 v[72:75], v5 offset:1024
  ds_read_b128 v[76:79], v5 offset:1280
  ds_read_b128 v[80:83], v5 offset:1536
  ds_read_b128 v[84:87], v5 offset:1792
  s_waitcnt lgkmcnt(7)
  v_mfma_f32_16x16x32_bf16 v[44:47], v[56:59], v[100:103], 0
  v_mfma_f32_16x16x32_bf16 v[40:43], v[56:59], v[96:99], 0
  s_waitcnt lgkmcnt(6)
  v_mfma_f32_16x16x32_bf16 v[44:47], v[60:63], v[108:111], v[44:47]
  v_mfma_f32_16x16x32_bf16 v[40:43], v[60:63], v[104:107], v[40:43]
  s_waitcnt lgkmcnt(5)
  v_mfma_f32_16x16x32_bf16 v[44:47], v[64:67], v[116:119], v[44:47]
  v_mfma_f32_16x16x32_bf16 v[40:43], v[64:67], v[112:115], v[40:43]
  s_waitcnt lgkmcnt(4)
  v_mfma_f32_16x16x32_bf16 v[44:47], v[68:71], v[124:127], v[44:47]
  v_mfma_f32_16x16x32_bf16 v[40:43], v[68:71], v[120:123], v[40:43]
  s_waitcnt lgkmcnt(3)
  v_mfma_f32_16x16x32_bf16 v[44:47], v[72:75], v[132:135], v[44:47]
  v_mfma_f32_16x16x32_bf16 v[40:43], v[72:75], v[128:131], v[40:43]
  s_waitcnt lgkmcnt(2)
  v_mfma_f32_16x16x32_bf16 v[44:47], v[76:79], v[140:143], v[44:47]
  v_mfma_f32_16x16x32_bf16 v[40:43], v[76:79], v[136:139], v[40:43]
  s_waitcnt lgkmcnt(1)
  v_mfma_f32_16x16x32_bf16 v[44:47], v[80:83], v[148:151], v[44:47]
  v_mfma_f32_16x16x32_bf16 v[40:43], v[80:83], v[144:147], v[40:43]
  s_waitcnt lgkmcnt(0)
  v_mfma_f32_16x16x32_bf16 v[44:47], v[84:87], v[156:159], v[44:47]
  v_mfma_f32_16x16x32_bf16 v[40:43], v[84:87], v[152:155], v[40:43]
  s_nop 6
  v_permlane32_swap_b32 v44, v48
  v_permlane32_swap_b32 v45, v49
  v_pk_add_f32 v[40:41], v[40:41], v[48:49]
  s_mov_b64 exec, 0xffff
  v_perm_b32 v40, v40, v11, s26
  v_perm_b32 v41, v41, v11, s27
  buffer_store_dwordx2 v[40:41], v17, s[16:19], s60 offen sc1
  s_branch L_exit
L_tail_ffn:
  v_bfe_u32 v14, v0, 4, 1
  v_lshlrev_b32 v33, 6, v14
  v_bfe_u32 v14, v0, 2, 1
  v_lshl_add_u32 v33, v14, 4, v33
  v_and_b32 v14, 3, v0
  v_lshl_add_u32 v33, v14, 1, v33
  s_and_b32 s53, s3, 1
  s_lshl_b32 s53, s53, 5
  s_bfe_u32 s54, s3, 0x10001
  s_lshl_b32 s54, s54, 3
  s_add_u32 s53, s53, s54
  s_add_u32 s53, s53, 2304
  v_add_u32 v33, s53, v33
  v_lshrrev_b32 v38, 2, v0
  v_mul_u32_u24 v38, 1152, v38
  v_lshl_add_u32 v38, v14, 3, v38
  s_lshl_b32 s53, s3, 7
  s_add_u32 s53, s53, 90112
  v_add_u32 v38, s53, v38
  v_bfe_u32 v39, v0, 3, 2
  v_mul_u32_u24 v39, 18560, v39
  v_and_b32 v14, 7, v0
  v_lshl_add_u32 v39, v14, 4, v39
  v_subrev_u32 v34, 3328, v5
  s_mul_i32 s62, s4, 18
  s_add_u32 s62, s62, s5
  s_sub_u32 s62, s62, 9
  s_lshl_b32 s61, s62, 7
  s_mul_i32 s53, s3, 74240
  s_add_u32 s61, s61, s53
  s_add_u32 s61, s61, 458752
  v_and_b32 v14, 7, v0
  v_mul_u32_u24 v30, 80, v14
  v_lshrrev_b32 v14, 4, v0
  v_lshl_add_u32 v30, v14, 4, v30
  v_bfe_u32 v14, v0, 3, 1
  v_mul_u32_u24 v14, 2688, v14
  v_add_u32 v30, v30, v14
  s_and_b32 s63, s62, 1
  s_mul_i32 s53, s63, 1344
  s_add_u32 s53, s53, 126976
  v_add_u32 v30, s53, v30
  s_lshl_b32 s63, s63, 2
  s_xor_b32 s63, s63, s3
  s_lshl_b32 s62, s62, 11
  s_add_u32 s62, s62, 1441792
  s_sub_u32 s53, s5, 9
  s_lshr_b32 s54, s53, 3
  s_lshl_b32 s54, s54, 6
  s_and_b32 s55, s53, 7
  s_add_u32 s54, s54, s55
  s_lshl3_add_u32 s54, s4, s54
  s_lshl_b32 s54, s54, 11
  s_add_u32 s54, s54, 131072
  s_cmp_lt_u32 s53, 16
  s_cselect_b32 s62, s54, s62
  v_xor_b32 v35, 0x5a5a5a5a, v11
  s_xor_b32 s30, s30, 0x5a
  s_xor_b32 s31, s31, 0x5a
  s_xor_b32 s32, s32, 0x5a
  s_xor_b32 s33, s33, 0x5a
  s_lshl_b32 s53, s3, 9
  s_add_u32 s62, s62, s53
  s_xor_b32 s59, s62, 2048
  v_lshlrev_b32 v18, 4, v0
  v_and_b32 v12, 31, v0
  s_mul_i32 s54, s3, 2688
  s_add_u32 s54, s54, 126976
  v_lshrrev_b32 v14, 5, v0
  v_mul_u32_u24 v4, 80, v14
  v_lshrrev_b32 v14, 4, v12
  v_mul_u32_u24 v14, 1344, v14
  v_add_u32 v4, v14, v4
  v_bfe_u32 v14, v12, 1, 2
  v_lshl_add_u32 v4, v14, 4, v4
  v_bfe_u32 v14, v12, 3, 1
  v_lshl_add_u32 v4, v14, 3, v4
  v_and_b32 v14, 1, v12
  v_lshl_add_u32 v4, v14, 2, v4
  v_add_u32 v4, s54, v4
  s_mul_i32 s53, s3, 2688
  v_subrev_u32 v31, s53, v4
  v_bfe_u32 v14, v0, 1, 1
  v_mul_u32_u24 v14, 0, v14
  v_add_u32 v14, s63, v14
  v_bfe_u32 v15, v0, 3, 2
  v_lshlrev_b32 v15, 1, v15
  v_xor_b32 v14, v14, v15
  v_lshrrev_b32 v7, 2, v0
  v_lshlrev_b32 v7, 7, v7
  v_lshl_add_u32 v7, v14, 4, v7
  v_and_b32 v14, 1, v0
  v_lshl_add_u32 v7, v14, 3, v7
  v_add_u32 v7, 16384, v7
  v_bfe_u32 v14, v0, 1, 1
  v_mul_u32_u24 v14, 36864, v14
  v_add_u32 v7, v7, v14
  v_xor_b32 v6, 64, v7
  v_mov_b32 v14, 0
L_lw_73:
  ds_read_b32 v15, v14 offset:56
  s_waitcnt lgkmcnt(0)
  v_readfirstlane_b32 s53, v15
  s_nop 0
  s_cmp_ge_u32 s53, 1
  s_cbranch_scc1 L_lwd_74
  s_add_u32 s80, s80, 1
  s_cmp_gt_u32 s80, 4000000
  s_cbranch_scc1 L_exit
  s_sleep 1
  s_branch L_lw_73
L_lwd_74:
  s_mov_b32 s81, s53
  s_mul_i32 s60, s4, 5120
  s_lshl_b32 s53, s3, 9
  s_add_u32 s60, s60, s53
  s_add_u32 s60, s60, 1130496
  s_mov_b32 s86, 0
  s_cmp_ge_u32 s3, 4
  s_cselect_b32 s85, 2, 0
  v_mov_b32 v36, 0
  v_mov_b32 v37, 1
  v_mov_b32 v14, 0
L_lw_75:
  ds_read_b32 v15, v14 offset:48
  s_waitcnt lgkmcnt(0)
  v_readfirstlane_b32 s53, v15
  s_nop 0
  s_cmp_eq_u32 s53, 1
  s_cbranch_scc1 L_lwd_76
  s_add_u32 s80, s80, 1
  s_cmp_gt_u32 s80, 4000000
  s_cbranch_scc1 L_exit
  s_sleep 1
  s_branch L_lw_75
L_lwd_76:
  ds_read_b32 v28, v4 offset:160
  s_waitcnt lgkmcnt(0)
  v_and_b32 v29, 0xffff0000, v28
  v_lshlrev_b32 v28, 16, v28
L_x1p:
  buffer_load_dwordx2 v[40:41], v10, s[16:19], s60 offen sc1
  s_cmp_eq_u32 s85, 2
  s_cbranch_scc1 L_ffn_nf
  ds_read_b32 v19, v14 offset:24
  s_waitcnt lgkmcnt(0)
  v_readfirstlane_b32 s85, v19
  s_nop 0
  s_cmp_eq_u32 s85, 2
  s_cbranch_scc0 L_ffn_nw
  ds_read_b64_tr_b16 v[96:97], v6 offset:0
  ds_read_b64_tr_b16 v[98:99], v6 offset:2048
  ds_read_b64_tr_b16 v[100:101], v6 offset:4096
  ds_read_b64_tr_b16 v[102:103], v6 offset:6144
  ds_read_b64_tr_b16 v[104:105], v6 offset:8192
  ds_read_b64_tr_b16 v[106:107], v6 offset:10240
  ds_read_b64_tr_b16 v[108:109], v6 offset:12288
  ds_read_b64_tr_b16 v[110:111], v6 offset:14336
  ds_read_b64_tr_b16 v[112:113], v6 offset:16384
  ds_read_b64_tr_b16 v[114:115], v6 offset:18432
  ds_read_b64_tr_b16 v[116:117], v6 offset:20480
  ds_read_b64_tr_b16 v[118:119], v6 offset:22528
  ds_read_b64_tr_b16 v[120:121], v6 offset:24576
  ds_read_b64_tr_b16 v[122:123], v6 offset:26624
  ds_read_b64_tr_b16 v[124:125], v6 offset:28672
  ds_read_b64_tr_b16 v[126:127], v6 offset:30720
  ds_read_b64_tr_b16 v[128:129], v6 offset:32768
  ds_read_b64_tr_b16 v[130:131], v6 offset:34816
  ds_read_b64_tr_b16 v[132:133], v7 offset:0
  ds_read_b64_tr_b16 v[134:135], v7 offset:2048
  ds_read_b64_tr_b16 v[136:137], v7 offset:4096
  ds_read_b64_tr_b16 v[138:139], v7 offset:6144
  ds_read_b64_tr_b16 v[140:141], v7 offset:8192
  ds_read_b64_tr_b16 v[142:143], v7 offset:10240
  ds_read_b64_tr_b16 v[144:145], v7 offset:12288
  ds_read_b64_tr_b16 v[146:147], v7 offset:14336
  ds_read_b64_tr_b16 v[148:149], v7 offset:16384
  ds_read_b64_tr_b16 v[150:151], v7 offset:18432
  ds_read_b64_tr_b16 v[152:153], v7 offset:20480
  ds_read_b64_tr_b16 v[154:155], v7 offset:22528
  ds_read_b64_tr_b16 v[156:157], v7 offset:24576
  ds_read_b64_tr_b16 v[158:159], v7 offset:26624
  ds_read_b64_tr_b16 v[160:161], v7 offset:28672
  ds_read_b64_tr_b16 v[162:163], v7 offset:30720
  ds_read_b64_tr_b16 v[164:165], v7 offset:32768
  ds_read_b64_tr_b16 v[166:167], v7 offset:34816
L_ffn_nf:
  s_cmp_eq_u32 s86, 2
  s_cbranch_scc1 L_ffn_nw
  ds_read_b32 v19, v14 offset:52
  s_waitcnt lgkmcnt(0)
  v_readfirstlane_b32 s86, v19
  s_nop 0
  s_cmp_eq_u32 s86, 2
  s_cbranch_scc0 L_ffn_nw
  ds_read_b64_tr_b16 v[80:81], v38 offset:0
  ds_read_b64_tr_b16 v[82:83], v38 offset:18432
  ds_read_b64_tr_b16 v[84:85], v38 offset:32
  ds_read_b64_tr_b16 v[86:87], v38 offset:18464
  ds_read_b64_tr_b16 v[88:89], v38 offset:64
  ds_read_b64_tr_b16 v[90:91], v38 offset:18496
  ds_read_b64_tr_b16 v[92:93], v38 offset:96
  ds_read_b64_tr_b16 v[94:95], v38 offset:18528
L_ffn_nw:
  s_add_u32 s80, s80, 1
  s_cmp_gt_u32 s80, 4000000
  s_cbranch_scc1 L_exit
  s_waitcnt vmcnt(0)
  v_cmp_ne_u32 vcc, s52, v41
  s_cbranch_vccnz L_x1p
  ds_write_b32 v4, v40 offset:640
  v_and_b32 v43, 0xffff0000, v40
  v_lshlrev_b32 v42, 16, v40
  v_pk_mul_f32 v[40:41], v[42:43], v[28:29]
  v_cvt_pk_bf16_f32 v15, v40, v41
  ds_write_b32 v4, v15
  v_lshlrev_b32 v42, 16, v15
  v_and_b32 v43, 0xffff0000, v15
  v_pk_add_f32 v[40:41], v[40:41], v[42:43] neg_lo:[0,1] neg_hi:[0,1]
  v_cvt_pk_bf16_f32 v14, v40, v41
  ds_write_b32 v4, v14 offset:480
  s_cmp_eq_u32 s85, 2
  s_cbranch_scc0 L_ffn_lf
L_ffn_b1:
  s_cmp_lt_u32 s3, 4
  s_waitcnt lgkmcnt(0)
  s_barrier
  s_cbranch_scc0 L_ffn_ot
  ds_read_b128 v[44:47], v30 offset:0
  ds_read_b128 v[48:51], v30 offset:5376
  ds_read_b128 v[52:55], v30 offset:10752
  ds_read_b128 v[56:59], v30 offset:16128
  ds_read_b128 v[60:63], v30 offset:21504
  s_waitcnt lgkmcnt(4)
  v_mfma_f32_16x16x32_bf16 v[68:71], v[44:47], v[100:103], 0
  v_mfma_f32_16x16x32_bf16 v[64:67], v[44:47], v[96:99], 0
  s_waitcnt lgkmcnt(3)
  v_mfma_f32_16x16x32_bf16 v[68:71], v[48:51], v[108:111], v[68:71]
  v_mfma_f32_16x16x32_bf16 v[64:67], v[48:51], v[104:107], v[64:67]
  s_waitcnt lgkmcnt(2)
  v_mfma_f32_16x16x32_bf16 v[68:71], v[52:55], v[116:119], v[68:71]
  v_mfma_f32_16x16x32_bf16 v[64:67], v[52:55], v[112:115], v[64:67]
  s_waitcnt lgkmcnt(1)
  v_mfma_f32_16x16x32_bf16 v[68:71], v[56:59], v[124:127], v[68:71]
  v_mfma_f32_16x16x32_bf16 v[64:67], v[56:59], v[120:123], v[64:67]
  s_waitcnt lgkmcnt(0)
  v_mfma_f32_16x16x32_bf16 v[64:67], v[60:63], v[128:131], v[64:67]
  v_mfma_f32_16x16x32_bf16 v[24:27], v[44:47], v[136:139], 0
  s_nop 3
  v_permlane32_swap_b32 v68, v72
  v_permlane32_swap_b32 v69, v73
  v_permlane32_swap_b32 v70, v74
  v_permlane32_swap_b32 v71, v75
  v_mfma_f32_16x16x32_bf16 v[20:23], v[44:47], v[132:135], 0
  v_pk_add_f32 v[64:65], v[64:65], v[72:73]
  v_pk_add_f32 v[66:67], v[66:67], v[74:75]
  v_perm_b32 v64, v64, v35, s26
  v_perm_b32 v65, v65, v35, s27
  v_perm_b32 v66, v66, v35, s28
  v_perm_b32 v67, v67, v35, s29
  s_mov_b32 exec_hi, 0
  s_cmp_eq_u32 s81, 1
  s_cbranch_scc0 L_ls_77
  buffer_store_dwordx4 v[64:67], v18, s[16:19], s62 offen
  s_branch L_lsd_78
L_ls_77:
  buffer_store_dwordx4 v[64:67], v18, s[16:19], s62 offen sc1
L_lsd_78:
  s_mov_b64 exec, -1
  v_mfma_f32_16x16x32_bf16 v[24:27], v[48:51], v[144:147], v[24:27]
  v_mfma_f32_16x16x32_bf16 v[20:23], v[48:51], v[140:143], v[20:23]
  v_mfma_f32_16x16x32_bf16 v[24:27], v[52:55], v[152:155], v[24:27]
  v_mfma_f32_16x16x32_bf16 v[20:23], v[52:55], v[148:151], v[20:23]
  v_mfma_f32_16x16x32_bf16 v[24:27], v[56:59], v[160:163], v[24:27]
  v_mfma_f32_16x16x32_bf16 v[20:23], v[56:59], v[156:159], v[20:23]
  v_mfma_f32_16x16x32_bf16 v[20:23], v[60:63], v[164:167], v[20:23]
  s_mov_b32 exec_hi, 0
  buffer_load_dwordx4 v[40:43], v18, s[16:19], s59 offen sc1
  s_mov_b64 exec, -1
  v_mov_b32 v14, 0
  v_cmp_gt_u32 vcc, 16, v0
  s_nop 0
  v_permlane32_swap_b32 v24, v72
  v_permlane32_swap_b32 v25, v73
  v_permlane32_swap_b32 v26, v74
  v_permlane32_swap_b32 v27, v75
  s_mov_b32 exec_hi, 0
  v_pk_add_f32 v[20:21], v[20:21], v[72:73]
  v_pk_add_f32 v[22:23], v[22:23], v[74:75]
L_cw:
  ds_read_b32 v15, v14 offset:60
  ds_read_b128 v[24:27], v14 offset:112
  s_add_u32 s80, s80, 1
  s_cmp_gt_u32 s80, 4000000
  s_cbranch_scc1 L_exit
  s_waitcnt lgkmcnt(0)
  v_readfirstlane_b32 s53, v15
  s_nop 0
  s_cmp_eq_u32 s53, 1
  s_cbranch_scc0 L_cw
  v_cndmask_b32 v24, v26, v24, vcc
  v_cndmask_b32 v25, v27, v25, vcc
  v_cndmask_b32 v26, 1.0, v26, vcc
  v_cndmask_b32 v27, 1.0, v27, vcc
  v_pk_mul_f32 v[20:21], v[20:21], v[26:27]
  v_pk_fma_f32 v[20:21], v[22:23], v[24:25], v[20:21]
  s_branch L_xp1
L_xp:
  buffer_load_dwordx4 v[40:43], v18, s[16:19], s59 offen sc1
  s_cmp_eq_u32 s86, 2
  s_cbranch_scc1 L_xp2
  v_mov_b32 v14, 0
  ds_read_b32 v19, v14 offset:52
  s_waitcnt lgkmcnt(0)
  v_readfirstlane_b32 s86, v19
  s_nop 0
  s_cmp_eq_u32 s86, 2
  s_cbranch_scc0 L_xp2
  s_mov_b64 exec, -1
  ds_read_b64_tr_b16 v[80:81], v38 offset:0
  ds_read_b64_tr_b16 v[82:83], v38 offset:18432
  ds_read_b64_tr_b16 v[84:85], v38 offset:32
  ds_read_b64_tr_b16 v[86:87], v38 offset:18464
  ds_read_b64_tr_b16 v[88:89], v38 offset:64
  ds_read_b64_tr_b16 v[90:91], v38 offset:18496
  ds_read_b64_tr_b16 v[92:93], v38 offset:96
  ds_read_b64_tr_b16 v[94:95], v38 offset:18528
  s_mov_b32 exec_hi, 0
L_xp2:
  s_add_u32 s80, s80, 1
  s_cmp_gt_u32 s80, 4000000
  s_cbranch_scc1 L_exit
L_xp1:
  s_waitcnt vmcnt(0)
  v_xor_b32 v40, s30, v40
  v_xor_b32 v41, s31, v41
  v_xor_b32 v42, s32, v42
  v_xor_b32 v43, s33, v43
  v_or3_b32 v14, v40, v41, v42
  v_or_b32 v14, v14, v43
  v_cmp_ne_u32_sdwa s[64:65], v14, s89 src0_sel:BYTE_0 src1_sel:DWORD
  v_pk_fma_f32 v[40:41], v[40:41], v[26:27], v[20:21]
  s_cmp_lg_u64 s[64:65], 0
  s_cbranch_scc1 L_xp
  v_pk_fma_f32 v[40:41], v[42:43], v[24:25], v[40:41]
  s_nop 1
  v_permlane16_swap_b32 v40, v41
  v_add_f32 v40, v40, v41
  s_nop 1
  v_mov_b32_dpp v41, v40 row_ror:8 row_mask:0xf bank_mask:0xf
  s_mov_b32 exec_lo, 0x00ff00ff
  v_cvt_pk_bf16_f32 v14, v40, v41
  v_lshlrev_b32 v40, 16, v14
  v_and_b32 v41, 0xffff0000, v14
  v_mul_f32 v14, 0xbfb8aa3b, v40
  v_exp_f32 v14, v14
  s_nop 0
  v_add_f32 v14, 1.0, v14
  v_rcp_f32 v14, v14
  s_nop 0
  v_mul_f32 v40, v40, v14
  v_cvt_pk_bf16_f32 v40, v40, v40
  v_lshlrev_b32 v40, 16, v40
  v_mul_f32 v40, v40, v41
  v_cvt_pk_bf16_f32 v40, v40, v40
  ds_write_b16 v33, v40
  s_mov_b64 exec, -1
L_ffn_w2:
  s_cmp_eq_u32 s86, 2
  s_cbranch_scc0 L_ffn_lw
L_ffn_b3:
  s_waitcnt lgkmcnt(0)
  s_barrier
  ds_read_b128 v[44:47], v34
  s_waitcnt lgkmcnt(0)
  v_mfma_f32_16x16x32_bf16 v[48:51], v[44:47], v[80:83], 0
  v_mfma_f32_16x16x32_bf16 v[52:55], v[44:47], v[84:87], 0
  v_mfma_f32_16x16x32_bf16 v[56:59], v[44:47], v[88:91], 0
  v_mfma_f32_16x16x32_bf16 v[60:63], v[44:47], v[92:95], 0
  s_mov_b32 exec_hi, 0
  s_nop 3
  v_perm_b32 v64, v48, v11, s26
  v_perm_b32 v65, v49, v11, s27
  v_perm_b32 v66, v52, v11, s28
  v_perm_b32 v67, v53, v11, s29
  s_mov_b32 exec_lo, 0xffff0000
  v_perm_b32 v64, v56, v11, s26
  v_perm_b32 v65, v57, v11, s27
  v_perm_b32 v66, v60, v11, s28
  v_perm_b32 v67, v61, v11, s29
  s_mov_b32 exec_lo, -1
  buffer_store_dwordx4 v[64:67], v39, s[16:19], s61 offen sc1
  s_branch L_exit
L_ffn_lf:
  v_mov_b32 v14, 0
L_lw_79:
  ds_read_b32 v15, v14 offset:24
  s_waitcnt lgkmcnt(0)
  v_readfirstlane_b32 s53, v15
  s_nop 0
  s_cmp_eq_u32 s53, 2
  s_cbranch_scc1 L_lwd_80
  s_add_u32 s80, s80, 1
  s_cmp_gt_u32 s80, 4000000
  s_cbranch_scc1 L_exit
  s_branch L_lw_79
L_lwd_80:
  ds_read_b64_tr_b16 v[96:97], v6 offset:0
  ds_read_b64_tr_b16 v[98:99], v6 offset:2048
  ds_read_b64_tr_b16 v[100:101], v6 offset:4096
  ds_read_b64_tr_b16 v[102:103], v6 offset:6144
  ds_read_b64_tr_b16 v[104:105], v6 offset:8192
  ds_read_b64_tr_b16 v[106:107], v6 offset:10240
  ds_read_b64_tr_b16 v[108:109], v6 offset:12288
  ds_read_b64_tr_b16 v[110:111], v6 offset:14336
  ds_read_b64_tr_b16 v[112:113], v6 offset:16384
  ds_read_b64_tr_b16 v[114:115], v6 offset:18432
  ds_read_b64_tr_b16 v[116:117], v6 offset:20480
  ds_read_b64_tr_b16 v[118:119], v6 offset:22528
  ds_read_b64_tr_b16 v[120:121], v6 offset:24576
  ds_read_b64_tr_b16 v[122:123], v6 offset:26624
  ds_read_b64_tr_b16 v[124:125], v6 offset:28672
  ds_read_b64_tr_b16 v[126:127], v6 offset:30720
  ds_read_b64_tr_b16 v[128:129], v6 offset:32768
  ds_read_b64_tr_b16 v[130:131], v6 offset:34816
  ds_read_b64_tr_b16 v[132:133], v7 offset:0
  ds_read_b64_tr_b16 v[134:135], v7 offset:2048
  ds_read_b64_tr_b16 v[136:137], v7 offset:4096
  ds_read_b64_tr_b16 v[138:139], v7 offset:6144
  ds_read_b64_tr_b16 v[140:141], v7 offset:8192
  ds_read_b64_tr_b16 v[142:143], v7 offset:10240
  ds_read_b64_tr_b16 v[144:145], v7 offset:12288
  ds_read_b64_tr_b16 v[146:147], v7 offset:14336
  ds_read_b64_tr_b16 v[148:149], v7 offset:16384
  ds_read_b64_tr_b16 v[150:151], v7 offset:18432
  ds_read_b64_tr_b16 v[152:153], v7 offset:20480
  ds_read_b64_tr_b16 v[154:155], v7 offset:22528
  ds_read_b64_tr_b16 v[156:157], v7 offset:24576
  ds_read_b64_tr_b16 v[158:159], v7 offset:26624
  ds_read_b64_tr_b16 v[160:161], v7 offset:28672
  ds_read_b64_tr_b16 v[162:163], v7 offset:30720
  ds_read_b64_tr_b16 v[164:165], v7 offset:32768
  ds_read_b64_tr_b16 v[166:167], v7 offset:34816
  s_branch L_ffn_b1
L_ffn_lw:
  v_mov_b32 v14, 0
L_lw_81:
  ds_read_b32 v15, v14 offset:52
  s_waitcnt lgkmcnt(0)
  v_readfirstlane_b32 s53, v15
  s_nop 0
  s_cmp_eq_u32 s53, 2
  s_cbranch_scc1 L_lwd_82
  s_add_u32 s80, s80, 1
  s_cmp_gt_u32 s80, 4000000
  s_cbranch_scc1 L_exit
  s_sleep 1
  s_branch L_lw_81
L_lwd_82:
  ds_read_b64_tr_b16 v[80:81], v38 offset:0
  ds_read_b64_tr_b16 v[82:83], v38 offset:18432
  ds_read_b64_tr_b16 v[84:85], v38 offset:32
  ds_read_b64_tr_b16 v[86:87], v38 offset:18464
  ds_read_b64_tr_b16 v[88:89], v38 offset:64
  ds_read_b64_tr_b16 v[90:91], v38 offset:18496
  ds_read_b64_tr_b16 v[92:93], v38 offset:96
  ds_read_b64_tr_b16 v[94:95], v38 offset:18528
  s_branch L_ffn_b3
L_ffn_ot:
  s_cmp_eq_u32 s3, 5
  s_cbranch_scc0 L_ffn_w2
  v_mov_b32 v28, 0x3f803f80
  v_lshrrev_b32 v29, 5, v0
  v_lshlrev_b32 v29, 2, v29
  ds_read_b32 v44, v31 offset:640
  ds_read_b32 v45, v31 offset:3328
  ds_read_b32 v46, v31 offset:6016
  ds_read_b32 v47, v31 offset:8704
  ds_read_b32 v48, v31 offset:11392
  ds_read_b32 v49, v31 offset:14080
  ds_read_b32 v50, v31 offset:16768
  ds_read_b32 v51, v31 offset:19456
  ds_read_b32 v52, v31 offset:22144
  s_waitcnt lgkmcnt(8)
  v_dot2_f32_bf16 v24, v44, v28, 0
  v_dot2_f32_bf16 v26, v44, v44, 0
  s_waitcnt lgkmcnt(7)
  v_dot2_f32_bf16 v24, v45, v28, v24
  v_dot2_f32_bf16 v26, v45, v45, v26
  s_waitcnt lgkmcnt(6)
  v_dot2_f32_bf16 v24, v46, v28, v24
  v_dot2_f32_bf16 v26, v46, v46, v26
  s_waitcnt lgkmcnt(5)
  v_dot2_f32_bf16 v24, v47, v28, v24
  v_dot2_f32_bf16 v26, v47, v47, v26
  s_waitcnt lgkmcnt(4)
  v_dot2_f32_bf16 v24, v48, v28, v24
  v_dot2_f32_bf16 v26, v48, v48, v26
  s_waitcnt lgkmcnt(3)
  v_dot2_f32_bf16 v24, v49, v28, v24
  v_dot2_f32_bf16 v26, v49, v49, v26
  s_waitcnt lgkmcnt(2)
  v_dot2_f32_bf16 v24, v50, v28, v24
  v_dot2_f32_bf16 v26, v50, v50, v26
  s_waitcnt lgkmcnt(1)
  v_dot2_f32_bf16 v24, v51, v28, v24
  v_dot2_f32_bf16 v26, v51, v51, v26
  s_waitcnt lgkmcnt(0)
  v_dot2_f32_bf16 v24, v52, v28, v24
  v_dot2_f32_bf16 v26, v52, v52, v26
  s_nop 1
  v_mov_b32 v25, v24
  v_mov_b32 v27, v26
  s_nop 0
  v_permlane16_swap_b32 v24, v25
  v_permlane16_swap_b32 v26, v27
  v_add_f32 v24, v24, v25
  v_add_f32 v26, v26, v27
  s_nop 0
  v_add_f32_dpp v24, v24, v24 row_ror:8 row_mask:0xf bank_mask:0xf
  v_add_f32_dpp v26, v26, v26 row_ror:8 row_mask:0xf bank_mask:0xf
  s_nop 0
  v_add_f32_dpp v24, v24, v24 row_ror:4 row_mask:0xf bank_mask:0xf
  v_add_f32_dpp v26, v26, v26 row_ror:4 row_mask:0xf bank_mask:0xf
  s_nop 0
  v_add_f32_dpp v24, v24, v24 row_ror:2 row_mask:0xf bank_mask:0xf
  v_add_f32_dpp v26, v26, v26 row_ror:2 row_mask:0xf bank_mask:0xf
  s_nop 0
  v_add_f32_dpp v24, v24, v24 row_ror:1 row_mask:0xf bank_mask:0xf
  v_add_f32_dpp v26, v26, v26 row_ror:1 row_mask:0xf bank_mask:0xf
  v_mul_f32 v24, 0x3ae38e39, v24
  v_mul_f32 v26, 0x3ae38e39, v26
  v_fma_f32 v26, -v24, v24, v26
  v_max_f32 v26, 0, v26
  v_cvt_pk_bf16_f32 v14, v24, v26
  v_lshlrev_b32 v24, 16, v14
  v_and_b32 v26, 0xffff0000, v14
  v_add_f32 v26, 0x3727c5ac, v26
  v_cvt_pk_bf16_f32 v26, v26, v26
  v_lshlrev_b32 v26, 16, v26
  v_sqrt_f32 v26, v26
  s_nop 0
  v_cvt_pk_bf16_f32 v26, v26, v26
  v_lshlrev_b32 v26, 16, v26
  v_rcp_f32 v26, v26
  s_nop 0
  v_mul_f32 v24, -v24, v26
  s_mov_b32 exec_lo, 1
  s_mov_b32 exec_hi, 1
  ds_write2_b32 v29, v24, v26 offset0:28 offset1:30
  s_mov_b64 exec, -1
  v_mov_b32 v14, 0
  v_mov_b32 v15, 1
  s_mov_b64 exec, 1
  ds_add_u32 v14, v15 offset:60
  s_mov_b64 exec, -1
  s_branch L_ffn_w2
L_H:
  s_mul_i32 s54, s56, 768
  s_add_u32 s54, s54, 5632
  v_and_b32 v12, 31, v0
  v_lshrrev_b32 v13, 5, v0
  v_lshlrev_b32 v1, 4, v12
  v_mul_u32_u24 v2, 1152, v13
  v_lshl_add_u32 v2, v12, 2, v2
  v_mul_u32_u24 v3, 0x0202, v13
  v_lshlrev_b32 v3, 16, v3
  v_add_u32 v3, 0x01000c0c, v3
  v_and_b32 v14, 1, v0
  v_lshlrev_b32 v5, 6, v14
  v_lshrrev_b32 v14, 4, v0
  v_lshl_add_u32 v5, v14, 4, v5
  v_add_u32 v5, s54, v5
  v_lshlrev_b32 v10, 3, v0
  v_lshrrev_b32 v14, 5, v0
  v_mul_u32_u24 v4, 64, v14
  v_lshrrev_b32 v14, 4, v12
  v_mul_u32_u24 v14, 128, v14
  v_add_u32 v4, v14, v4
  v_bfe_u32 v14, v12, 1, 2
  v_lshl_add_u32 v4, v14, 4, v4
  v_bfe_u32 v14, v12, 3, 1
  v_lshl_add_u32 v4, v14, 3, v4
  v_and_b32 v14, 1, v12
  v_lshl_add_u32 v4, v14, 2, v4
  v_add_u32 v4, s54, v4
  s_mul_i32 s54, s56, 24576
  s_add_u32 s54, s54, 16384
  v_bfe_u32 v14, v0, 1, 1
  v_mul_u32_u24 v14, 1, v14
  v_add_u32 v14, 0, v14
  v_bfe_u32 v15, v0, 3, 2
  v_lshlrev_b32 v15, 1, v15
  v_xor_b32 v14, v14, v15
  v_lshrrev_b32 v6, 2, v0
  v_lshlrev_b32 v6, 7, v6
  v_lshl_add_u32 v6, v14, 4, v6
  v_and_b32 v14, 1, v0
  v_lshl_add_u32 v6, v14, 3, v6
  v_add_u32 v6, s54, v6
  v_xor_b32 v7, 32, v6
  v_xor_b32 v8, 64, v6
  v_xor_b32 v9, 0x60, v6
  s_mov_b32 s16, s50
  s_mov_b32 s17, s51
  s_mov_b32 s18, 268435456
  s_mov_b32 s19, 0x20000
  s_cmp_lt_u32 s83, 3
  s_cbranch_scc1 L_f_some
  s_waitcnt vmcnt(0)
  s_branch L_f_next
L_f_some:
  s_cmp_lt_u32 s5, 24
  s_cbranch_scc1 L_f_wq
  s_mul_i32 s85, s83, 18432
  s_lshl_b32 s53, s84, 9
  s_add_u32 s85, s85, s53
  s_add_u32 s85, s85, 1179648
  s_movk_i32 s87, 9216
  s_waitcnt vmcnt(16)
  v_and_b32 v17, 0xffff0000, v16
  v_lshlrev_b32 v16, 16, v16
  v_mul_f32 v24, 0xbfb8aa3b, v16
  s_mov_b32 s53, 0xbfb8aa3b
  v_fma_f32 v25, v16, s53, -v24
  s_mov_b32 s53, 0xb2a57060
  v_fma_f32 v25, v16, s53, v25
  v_exp_f32 v24, v24
  v_mul_f32 v25, 0x3f317218, v25
  v_min_f32 v24, 0x7e800000, v24
  v_fma_f32 v24, v24, v25, v24
  v_add_f32 v24, 1.0, v24
  v_rcp_f32 v25, v24
  s_nop 0
  v_mul_f32 v26, v16, v25
  v_fma_f32 v16, -v26, v24, v16
  v_fma_f32 v16, v16, v25, v26
  v_mul_f32 v24, 0xbfb8aa3b, v17
  s_mov_b32 s53, 0xbfb8aa3b
  v_fma_f32 v25, v17, s53, -v24
  s_mov_b32 s53, 0xb2a57060
  v_fma_f32 v25, v17, s53, v25
  v_exp_f32 v24, v24
  v_mul_f32 v25, 0x3f317218, v25
  v_min_f32 v24, 0x7e800000, v24
  v_fma_f32 v24, v24, v25, v24
  v_add_f32 v24, 1.0, v24
  v_rcp_f32 v25, v24
  s_nop 0
  v_mul_f32 v26, v17, v25
  v_fma_f32 v17, -v26, v24, v17
  v_fma_f32 v17, v17, v25, v26
  v_cvt_pk_bf16_f32 v14, v16, v17
  ds_write_b32 v4, v14
  v_mov_b32 v14, 0
L_lw_83:
  ds_read_b32 v15, v14 offset:4
  s_waitcnt lgkmcnt(0)
  v_readfirstlane_b32 s53, v15
  s_nop 0
  s_cmp_eq_u32 s53, 1
  s_cbranch_scc1 L_lwd_84
  s_add_u32 s80, s80, 1
  s_cmp_gt_u32 s80, 4000000
  s_cbranch_scc1 L_exit
  s_sleep 1
  s_branch L_lw_83
L_lwd_84:
  ds_read_b32 v15, v14 offset:0
  s_waitcnt lgkmcnt(0)
  v_readfirstlane_b32 s52, v15
  s_mov_b32 s81, 2
  s_waitcnt vmcnt(0)
  ds_read_b64_tr_b16 v[72:73], v6 offset:0
  ds_read_b64_tr_b16 v[74:75], v6 offset:2048
  ds_read_b64_tr_b16 v[76:77], v7 offset:0
  ds_read_b64_tr_b16 v[78:79], v7 offset:2048
  ds_read_b64_tr_b16 v[80:81], v8 offset:0
  ds_read_b64_tr_b16 v[82:83], v8 offset:2048
  ds_read_b64_tr_b16 v[84:85], v9 offset:0
  ds_read_b64_tr_b16 v[86:87], v9 offset:2048
  ds_read_b64_tr_b16 v[88:89], v6 offset:4096
  ds_read_b64_tr_b16 v[90:91], v6 offset:6144
  ds_read_b64_tr_b16 v[92:93], v7 offset:4096
  ds_read_b64_tr_b16 v[94:95], v7 offset:6144
  ds_read_b64_tr_b16 v[96:97], v8 offset:4096
  ds_read_b64_tr_b16 v[98:99], v8 offset:6144
  ds_read_b64_tr_b16 v[100:101], v9 offset:4096
  ds_read_b64_tr_b16 v[102:103], v9 offset:6144
  ds_read_b64_tr_b16 v[104:105], v6 offset:8192
  ds_read_b64_tr_b16 v[106:107], v6 offset:10240
  ds_read_b64_tr_b16 v[108:109], v7 offset:8192
  ds_read_b64_tr_b16 v[110:111], v7 offset:10240
  ds_read_b64_tr_b16 v[112:113], v8 offset:8192
  ds_read_b64_tr_b16 v[114:115], v8 offset:10240
  ds_read_b64_tr_b16 v[116:117], v9 offset:8192
  ds_read_b64_tr_b16 v[118:119], v9 offset:10240
  ds_read_b64_tr_b16 v[120:121], v6 offset:12288
  ds_read_b64_tr_b16 v[122:123], v6 offset:14336
  ds_read_b64_tr_b16 v[124:125], v7 offset:12288
  ds_read_b64_tr_b16 v[126:127], v7 offset:14336
  ds_read_b64_tr_b16 v[128:129], v8 offset:12288
  ds_read_b64_tr_b16 v[130:131], v8 offset:14336
  ds_read_b64_tr_b16 v[132:133], v9 offset:12288
  ds_read_b64_tr_b16 v[134:135], v9 offset:14336
  s_branch L_f_mm
L_f_wq:
  s_lshr_b32 s85, s84, 2
  s_lshl2_add_u32 s85, s85, s83
  s_lshl_b32 s85, s85, 11
  s_and_b32 s53, s84, 3
  s_lshl_b32 s53, s53, 9
  s_add_u32 s85, s85, s53
  s_add_u32 s85, s85, 131072
  s_mov_b32 s87, 0x20000
  v_lshrrev_b32 v37, 5, v0
  v_mul_u32_u24 v37, 9216, v37
  v_add_u32 v37, v37, v1
  s_lshl_b32 s53, s86, 9
  v_add_u32 v37, s53, v37
  v_add_u32 v38, 4608, v37
  s_mov_b32 s60, 1179648
  s_mov_b32 s61, 1198080
  s_mov_b32 s62, 1216512
  s_waitcnt vmcnt(16)
  v_and_b32 v17, 0xffff0000, v16
  v_lshlrev_b32 v16, 16, v16
  v_and_b32 v45, 0xffff0000, v44
  v_lshlrev_b32 v44, 16, v44
  v_and_b32 v47, 0xffff0000, v46
  v_lshlrev_b32 v46, 16, v46
  v_and_b32 v49, 0xffff0000, v48
  v_lshlrev_b32 v48, 16, v48
  v_and_b32 v51, 0xffff0000, v50
  v_lshlrev_b32 v50, 16, v50
  v_and_b32 v53, 0xffff0000, v52
  v_lshlrev_b32 v52, 16, v52
  v_and_b32 v55, 0xffff0000, v54
  v_lshlrev_b32 v54, 16, v54
  v_and_b32 v57, 0xffff0000, v56
  v_lshlrev_b32 v56, 16, v56
  v_and_b32 v59, 0xffff0000, v58
  v_lshlrev_b32 v58, 16, v58
  v_and_b32 v61, 0xffff0000, v60
  v_lshlrev_b32 v60, 16, v60
  v_add_f32 v34, v44, v45
  v_add_f32 v34, v34, v46
  v_add_f32 v34, v34, v47
  v_add_f32 v34, v34, v48
  v_add_f32 v34, v34, v49
  v_add_f32 v34, v34, v50
  v_add_f32 v34, v34, v51
  v_add_f32 v34, v34, v52
  v_add_f32 v34, v34, v53
  v_add_f32 v34, v34, v54
  v_add_f32 v34, v34, v55
  v_add_f32 v34, v34, v56
  v_add_f32 v34, v34, v57
  v_add_f32 v34, v34, v58
  v_add_f32 v34, v34, v59
  v_add_f32 v34, v34, v60
  v_add_f32 v34, v34, v61
  v_mov_b32 v35, v34
  s_nop 1
  v_permlane16_swap_b32 v34, v35
  v_add_f32 v34, v34, v35
  s_nop 1
  v_add_f32_dpp v34, v34, v34 row_ror:8 row_mask:0xf bank_mask:0xf
  s_nop 1
  v_add_f32_dpp v34, v34, v34 row_ror:4 row_mask:0xf bank_mask:0xf
  s_nop 1
  v_add_f32_dpp v34, v34, v34 row_ror:2 row_mask:0xf bank_mask:0xf
  s_nop 1
  v_add_f32_dpp v34, v34, v34 row_ror:1 row_mask:0xf bank_mask:0xf
  v_mul_f32 v34, 0x3ae38e39, v34
  v_mov_b32 v35, 0
  v_sub_f32 v36, v44, v34
  v_fmac_f32 v35, v36, v36
  v_sub_f32 v36, v45, v34
  v_fmac_f32 v35, v36, v36
  v_sub_f32 v36, v46, v34
  v_fmac_f32 v35, v36, v36
  v_sub_f32 v36, v47, v34
  v_fmac_f32 v35, v36, v36
  v_sub_f32 v36, v48, v34
  v_fmac_f32 v35, v36, v36
  v_sub_f32 v36, v49, v34
  v_fmac_f32 v35, v36, v36
  v_sub_f32 v36, v50, v34
  v_fmac_f32 v35, v36, v36
  v_sub_f32 v36, v51, v34
  v_fmac_f32 v35, v36, v36
  v_sub_f32 v36, v52, v34
  v_fmac_f32 v35, v36, v36
  v_sub_f32 v36, v53, v34
  v_fmac_f32 v35, v36, v36
  v_sub_f32 v36, v54, v34
  v_fmac_f32 v35, v36, v36
  v_sub_f32 v36, v55, v34
  v_fmac_f32 v35, v36, v36
  v_sub_f32 v36, v56, v34
  v_fmac_f32 v35, v36, v36
  v_sub_f32 v36, v57, v34
  v_fmac_f32 v35, v36, v36
  v_sub_f32 v36, v58, v34
  v_fmac_f32 v35, v36, v36
  v_sub_f32 v36, v59, v34
  v_fmac_f32 v35, v36, v36
  v_sub_f32 v36, v60, v34
  v_fmac_f32 v35, v36, v36
  v_sub_f32 v36, v61, v34
  v_fmac_f32 v35, v36, v36
  v_mov_b32 v36, v35
  s_nop 1
  v_permlane16_swap_b32 v35, v36
  v_add_f32 v35, v35, v36
  s_nop 1
  v_add_f32_dpp v35, v35, v35 row_ror:8 row_mask:0xf bank_mask:0xf
  s_nop 1
  v_add_f32_dpp v35, v35, v35 row_ror:4 row_mask:0xf bank_mask:0xf
  s_nop 1
  v_add_f32_dpp v35, v35, v35 row_ror:2 row_mask:0xf bank_mask:0xf
  s_nop 1
  v_add_f32_dpp v35, v35, v35 row_ror:1 row_mask:0xf bank_mask:0xf
  v_mul_f32 v35, 0x3ae38e39, v35
  s_cmp_lg_u32 s3, 8
  s_cbranch_scc1 L_nqp
  v_and_b32 v18, 7, v0
  v_lshlrev_b32 v18, 7, v18
  v_bfe_u32 v19, v0, 3, 1
  v_lshl_add_u32 v18, v19, 17, v18
  s_mov_b64 exec, 0xffff
  buffer_load_dword v70, v18, s[16:19], s85 offen nt
  buffer_load_dword v71, v18, s[16:19], s85 offen sc1
  s_mov_b64 exec, -1
L_nqp:
  v_cvt_pk_bf16_f32 v14, v34, v35
  v_lshlrev_b32 v34, 16, v14
  v_and_b32 v35, 0xffff0000, v14
  v_add_f32 v35, 0x3727c5ac, v35
  v_cvt_pk_bf16_f32 v35, v35, v35
  v_lshlrev_b32 v35, 16, v35
  v_sqrt_f32 v35, v35
  s_nop 0
  v_cvt_pk_bf16_f32 v35, v35, v35
  v_lshlrev_b32 v35, 16, v35
  v_rcp_f32 v35, v35
  v_sub_f32 v16, v16, v34
  v_sub_f32 v17, v17, v34
  v_cvt_pk_bf16_f32 v14, v16, v17
  v_lshlrev_b32 v16, 16, v14
  v_and_b32 v17, 0xffff0000, v14
  v_mul_f32 v16, v16, v35
  v_mul_f32 v17, v17, v35
  v_cvt_pk_bf16_f32 v14, v16, v17
  v_lshlrev_b32 v16, 16, v14
  v_and_b32 v17, 0xffff0000, v14
  v_mov_b32 v14, 0
L_lw_85:
  ds_read_b32 v15, v14 offset:4
  s_waitcnt lgkmcnt(0)
  v_readfirstlane_b32 s53, v15
  s_nop 0
  s_cmp_eq_u32 s53, 1
  s_cbranch_scc1 L_lwd_86
  s_add_u32 s80, s80, 1
  s_cmp_gt_u32 s80, 4000000
  s_cbranch_scc1 L_exit
  s_sleep 1
  s_branch L_lw_85
L_lwd_86:
  ds_read_b32 v15, v14 offset:0
  s_waitcnt lgkmcnt(0)
  v_readfirstlane_b32 s52, v15
  v_mov_b32 v14, 0
L_lw_87:
  ds_read_b32 v15, v14 offset:36
  s_waitcnt lgkmcnt(0)
  v_readfirstlane_b32 s53, v15
  s_nop 0
  s_cmp_ge_u32 s53, 14
  s_cbranch_scc1 L_lwd_88
  s_add_u32 s80, s80, 1
  s_cmp_gt_u32 s80, 4000000
  s_cbranch_scc1 L_exit
  s_sleep 4
  s_branch L_lw_87
L_lwd_88:
  buffer_load_dwordx4 v[40:43], v37, s[16:19], s60 offen sc1
  buffer_load_dwordx4 v[44:47], v37, s[16:19], s61 offen sc1
  buffer_load_dwordx4 v[48:51], v37, s[16:19], s62 offen sc1
  buffer_load_dwordx4 v[52:55], v38, s[16:19], s60 offen sc1
  buffer_load_dwordx4 v[56:59], v38, s[16:19], s61 offen sc1
  buffer_load_dwordx4 v[60:63], v38, s[16:19], s62 offen sc1
  s_branch L_polle_91
L_poll_89:
  s_mov_b64 exec, s[64:65]
  buffer_load_dwordx4 v[40:43], v37, s[16:19], s60 offen sc1
  s_mov_b64 exec, s[66:67]
  buffer_load_dwordx4 v[44:47], v37, s[16:19], s61 offen sc1
  s_mov_b64 exec, s[68:69]
  buffer_load_dwordx4 v[48:51], v37, s[16:19], s62 offen sc1
  s_mov_b64 exec, s[70:71]
  buffer_load_dwordx4 v[52:55], v38, s[16:19], s60 offen sc1
  s_mov_b64 exec, s[72:73]
  buffer_load_dwordx4 v[56:59], v38, s[16:19], s61 offen sc1
  s_mov_b64 exec, s[74:75]
  buffer_load_dwordx4 v[60:63], v38, s[16:19], s62 offen sc1
  s_mov_b64 exec, -1
  s_add_u32 s80, s80, 1
  s_cmp_gt_u32 s80, 4000000
  s_cbranch_scc1 L_exit
L_polle_91:
  s_waitcnt vmcnt(5)
  v_xor_b32 v14, s52, v41
  v_xor_b32 v15, s52, v43
  v_or_b32 v14, v14, v15
  v_cmp_ne_u32 s[64:65], 0, v14
  s_waitcnt vmcnt(4)
  v_xor_b32 v14, s52, v45
  v_xor_b32 v15, s52, v47
  v_or_b32 v14, v14, v15
  v_cmp_ne_u32 s[66:67], 0, v14
  s_waitcnt vmcnt(3)
  v_xor_b32 v14, s52, v49
  v_xor_b32 v15, s52, v51
  v_or_b32 v14, v14, v15
  v_cmp_ne_u32 s[68:69], 0, v14
  s_waitcnt vmcnt(2)
  v_xor_b32 v14, s52, v53
  v_xor_b32 v15, s52, v55
  v_or_b32 v14, v14, v15
  v_cmp_ne_u32 s[70:71], 0, v14
  s_waitcnt vmcnt(1)
  v_xor_b32 v14, s52, v57
  v_xor_b32 v15, s52, v59
  v_or_b32 v14, v14, v15
  v_cmp_ne_u32 s[72:73], 0, v14
  s_waitcnt vmcnt(0)
  v_xor_b32 v14, s52, v61
  v_xor_b32 v15, s52, v63
  v_or_b32 v14, v14, v15
  v_cmp_ne_u32 s[74:75], 0, v14
  s_or_b64 s[54:55], s[64:65], s[66:67]
  s_or_b64 s[54:55], s[54:55], s[68:69]
  s_or_b64 s[54:55], s[54:55], s[70:71]
  s_or_b64 s[54:55], s[54:55], s[72:73]
  s_or_b64 s[54:55], s[54:55], s[74:75]
  s_cbranch_scc0 L_polld_90
  s_sleep 4
  s_branch L_poll_89
L_polld_90:
  s_waitcnt vmcnt(0)
  ds_read_b64_tr_b16 v[72:73], v6 offset:0
  ds_read_b64_tr_b16 v[74:75], v6 offset:2048
  ds_read_b64_tr_b16 v[76:77], v7 offset:0
  ds_read_b64_tr_b16 v[78:79], v7 offset:2048
  ds_read_b64_tr_b16 v[80:81], v8 offset:0
  ds_read_b64_tr_b16 v[82:83], v8 offset:2048
  ds_read_b64_tr_b16 v[84:85], v9 offset:0
  ds_read_b64_tr_b16 v[86:87], v9 offset:2048
  ds_read_b64_tr_b16 v[88:89], v6 offset:4096
  ds_read_b64_tr_b16 v[90:91], v6 offset:6144
  ds_read_b64_tr_b16 v[92:93], v7 offset:4096
  ds_read_b64_tr_b16 v[94:95], v7 offset:6144
  ds_read_b64_tr_b16 v[96:97], v8 offset:4096
  ds_read_b64_tr_b16 v[98:99], v8 offset:6144
  ds_read_b64_tr_b16 v[100:101], v9 offset:4096
  ds_read_b64_tr_b16 v[102:103], v9 offset:6144
  ds_read_b64_tr_b16 v[104:105], v6 offset:8192
  ds_read_b64_tr_b16 v[106:107], v6 offset:10240
  ds_read_b64_tr_b16 v[108:109], v7 offset:8192
  ds_read_b64_tr_b16 v[110:111], v7 offset:10240
  ds_read_b64_tr_b16 v[112:113], v8 offset:8192
  ds_read_b64_tr_b16 v[114:115], v8 offset:10240
  ds_read_b64_tr_b16 v[116:117], v9 offset:8192
  ds_read_b64_tr_b16 v[118:119], v9 offset:10240
  ds_read_b64_tr_b16 v[120:121], v6 offset:12288
  ds_read_b64_tr_b16 v[122:123], v6 offset:14336
  ds_read_b64_tr_b16 v[124:125], v7 offset:12288
  ds_read_b64_tr_b16 v[126:127], v7 offset:14336
  ds_read_b64_tr_b16 v[128:129], v8 offset:12288
  ds_read_b64_tr_b16 v[130:131], v8 offset:14336
  ds_read_b64_tr_b16 v[132:133], v9 offset:12288
  ds_read_b64_tr_b16 v[134:135], v9 offset:14336
  v_add_f32 v40, v40, v44
  v_add_f32 v40, v40, v48
  v_add_f32 v42, v42, v46
  v_add_f32 v42, v42, v50
  v_add_f32 v52, v52, v56
  v_add_f32 v52, v52, v60
  v_add_f32 v54, v54, v58
  v_add_f32 v54, v54, v62
  v_cvt_pk_bf16_f32 v14, v40, v42
  v_lshlrev_b32 v40, 16, v14
  v_and_b32 v42, 0xffff0000, v14
  v_cvt_pk_bf16_f32 v14, v52, v54
  v_lshlrev_b32 v52, 16, v14
  v_and_b32 v54, 0xffff0000, v14
  v_add_f32 v52, 1.0, v52
  v_add_f32 v54, 1.0, v54
  v_cvt_pk_bf16_f32 v14, v52, v54
  v_lshlrev_b32 v52, 16, v14
  v_and_b32 v54, 0xffff0000, v14
  v_mul_f32 v16, v16, v52
  v_mul_f32 v17, v17, v54
  v_cvt_pk_bf16_f32 v14, v16, v17
  v_lshlrev_b32 v16, 16, v14
  v_and_b32 v17, 0xffff0000, v14
  v_add_f32 v16, v16, v40
  v_add_f32 v17, v17, v42
  v_cvt_pk_bf16_f32 v14, v16, v17
  ds_write_b32 v4, v14
  v_mov_b32 v14, 0
L_lw_92:
  ds_read_b32 v15, v14 offset:56
  s_waitcnt lgkmcnt(0)
  v_readfirstlane_b32 s53, v15
  s_nop 0
  s_cmp_ge_u32 s53, 1
  s_cbranch_scc1 L_lwd_93
  s_add_u32 s80, s80, 1
  s_cmp_gt_u32 s80, 4000000
  s_cbranch_scc1 L_exit
  s_sleep 1
  s_branch L_lw_92
L_lwd_93:
  s_mov_b32 s81, s53
L_f_mm:
  s_waitcnt lgkmcnt(0)
  ds_read_b128 v[16:19], v5 offset:0
  ds_read_b128 v[20:23], v5 offset:128
  s_waitcnt lgkmcnt(1)
  v_mfma_f32_16x16x32_bf16 v[40:43], v[16:19], v[72:75], 0
  v_mfma_f32_16x16x32_bf16 v[44:47], v[16:19], v[76:79], 0
  v_mfma_f32_16x16x32_bf16 v[48:51], v[16:19], v[80:83], 0
  v_mfma_f32_16x16x32_bf16 v[52:55], v[16:19], v[84:87], 0
  s_waitcnt lgkmcnt(0)
  v_mfma_f32_16x16x32_bf16 v[40:43], v[20:23], v[88:91], v[40:43]
  v_mfma_f32_16x16x32_bf16 v[44:47], v[20:23], v[92:95], v[44:47]
  v_mfma_f32_16x16x32_bf16 v[48:51], v[20:23], v[96:99], v[48:51]
  v_mfma_f32_16x16x32_bf16 v[52:55], v[20:23], v[100:103], v[52:55]
  s_nop 5
  v_mov_b32_dpp v40, v44 quad_perm:[0,1,2,3] row_mask:0x2 bank_mask:0xf
  v_mov_b32_dpp v41, v45 quad_perm:[0,1,2,3] row_mask:0x2 bank_mask:0xf
  s_nop 0
  v_mov_b32_dpp v40, v48 quad_perm:[0,1,2,3] row_mask:0x4 bank_mask:0xf
  v_mov_b32_dpp v41, v49 quad_perm:[0,1,2,3] row_mask:0x4 bank_mask:0xf
  s_nop 0
  v_mov_b32_dpp v40, v52 quad_perm:[0,1,2,3] row_mask:0x8 bank_mask:0xf
  v_mov_b32_dpp v41, v53 quad_perm:[0,1,2,3] row_mask:0x8 bank_mask:0xf
  s_lshl_b32 s53, s56, 9
  v_add_u32 v14, s53, v10
  ds_write_b64 v14, v[40:41] offset:2560
  v_mov_b32 v14, 0
  v_mov_b32 v15, 1
  s_mov_b64 exec, 1
  ds_add_rtn_u32 v15, v14, v15 offset:40
  s_mov_b64 exec, -1
  s_waitcnt lgkmcnt(0)
  v_readfirstlane_b32 s53, v15
  s_nop 0
  s_cmp_eq_u32 s53, 2
  s_cbranch_scc0 L_f_h1
  ds_read_b128 v[40:43], v1 offset:2560
  ds_read_b128 v[44:47], v1 offset:3072
  ds_read_b128 v[48:51], v1 offset:3584
  s_waitcnt lgkmcnt(0)
  v_add_f32 v40, v40, v44
  v_add_f32 v41, v41, v45
  v_add_f32 v42, v42, v46
  v_add_f32 v43, v43, v47
  v_add_f32 v40, v40, v48
  v_add_f32 v41, v41, v49
  v_add_f32 v42, v42, v50
  v_add_f32 v43, v43, v51
  v_cmp_gt_u32 vcc, 32, v0
  v_lshrrev_b32 v14, 5, v0
  v_mul_u32_u24 v14, s87, v14
  v_cndmask_b32 v40, v41, v40, vcc
  v_cndmask_b32 v42, v43, v42, vcc
  v_add_u32 v14, v14, v1
  v_mov_b32 v41, s52
  v_mov_b32 v43, s52
  s_cmp_eq_u32 s81, 1
  s_cbranch_scc0 L_ls_94
  buffer_store_dwordx4 v[40:43], v14, s[16:19], s85 offen
  s_branch L_lsd_95
L_ls_94:
  buffer_store_dwordx4 v[40:43], v14, s[16:19], s85 offen sc1
L_lsd_95:
L_f_h1:
  s_lshl2_add_u32 s85, s59, s85
  ds_read_b128 v[16:19], v5 offset:0
  ds_read_b128 v[20:23], v5 offset:128
  s_waitcnt lgkmcnt(1)
  v_mfma_f32_16x16x32_bf16 v[40:43], v[16:19], v[104:107], 0
  v_mfma_f32_16x16x32_bf16 v[44:47], v[16:19], v[108:111], 0
  v_mfma_f32_16x16x32_bf16 v[48:51], v[16:19], v[112:115], 0
  v_mfma_f32_16x16x32_bf16 v[52:55], v[16:19], v[116:119], 0
  s_waitcnt lgkmcnt(0)
  v_mfma_f32_16x16x32_bf16 v[40:43], v[20:23], v[120:123], v[40:43]
  v_mfma_f32_16x16x32_bf16 v[44:47], v[20:23], v[124:127], v[44:47]
  v_mfma_f32_16x16x32_bf16 v[48:51], v[20:23], v[128:131], v[48:51]
  v_mfma_f32_16x16x32_bf16 v[52:55], v[20:23], v[132:135], v[52:55]
  s_nop 5
  v_mov_b32_dpp v40, v44 quad_perm:[0,1,2,3] row_mask:0x2 bank_mask:0xf
  v_mov_b32_dpp v41, v45 quad_perm:[0,1,2,3] row_mask:0x2 bank_mask:0xf
  s_nop 0
  v_mov_b32_dpp v40, v48 quad_perm:[0,1,2,3] row_mask:0x4 bank_mask:0xf
  v_mov_b32_dpp v41, v49 quad_perm:[0,1,2,3] row_mask:0x4 bank_mask:0xf
  s_nop 0
  v_mov_b32_dpp v40, v52 quad_perm:[0,1,2,3] row_mask:0x8 bank_mask:0xf
  v_mov_b32_dpp v41, v53 quad_perm:[0,1,2,3] row_mask:0x8 bank_mask:0xf
  s_lshl_b32 s53, s56, 9
  v_add_u32 v14, s53, v10
  ds_write_b64 v14, v[40:41] offset:4096
  v_mov_b32 v14, 0
  v_mov_b32 v15, 1
  s_mov_b64 exec, 1
  ds_add_rtn_u32 v15, v14, v15 offset:44
  s_mov_b64 exec, -1
  s_waitcnt lgkmcnt(0)
  v_readfirstlane_b32 s53, v15
  s_nop 0
  s_cmp_eq_u32 s53, 2
  s_cbranch_scc0 L_f_next
  ds_read_b128 v[40:43], v1 offset:4096
  ds_read_b128 v[44:47], v1 offset:4608
  ds_read_b128 v[48:51], v1 offset:5120
  s_waitcnt lgkmcnt(0)
  v_add_f32 v40, v40, v44
  v_add_f32 v41, v41, v45
  v_add_f32 v42, v42, v46
  v_add_f32 v43, v43, v47
  v_add_f32 v40, v40, v48
  v_add_f32 v41, v41, v49
  v_add_f32 v42, v42, v50
  v_add_f32 v43, v43, v51
  v_cmp_gt_u32 vcc, 32, v0
  v_lshrrev_b32 v14, 5, v0
  v_mul_u32_u24 v14, s87, v14
  v_cndmask_b32 v40, v41, v40, vcc
  v_cndmask_b32 v42, v43, v42, vcc
  v_add_u32 v14, v14, v1
  v_mov_b32 v41, s52
  v_mov_b32 v43, s52
  s_cmp_eq_u32 s81, 1
  s_cbranch_scc0 L_ls_96
  buffer_store_dwordx4 v[40:43], v14, s[16:19], s85 offen
  s_branch L_lsd_97
L_ls_96:
  buffer_store_dwordx4 v[40:43], v14, s[16:19], s85 offen sc1
L_lsd_97:
L_f_next:
  s_cmp_lt_u32 s5, 9
  s_cbranch_scc1 L_f_wo
  s_cmp_lt_u32 s5, 27
  s_cbranch_scc1 L_f_done
  s_sub_u32 s84, s2, 198
  s_cmp_lt_u32 s84, 54
  s_cbranch_scc0 L_t_done
  s_mov_b32 s20, s42
  s_mov_b32 s21, s43
  s_mov_b32 s22, 2304
  s_mov_b32 s23, 0x20000
  s_mul_i32 s53, s56, 384
  buffer_load_dword v16, v2, s[20:23], s53 offen offset:0
  buffer_load_dword v18, v2, s[20:23], s53 offen offset:128
  buffer_load_dword v20, v2, s[20:23], s53 offen offset:256
  s_lshl_b32 s53, s84, 7
  s_add_u32 s60, s44, s53
  s_addc_u32 s61, s45, 0
  s_mov_b32 s62, s60
  s_mov_b32 s63, s61
  s_mov_b32 s59, 6912
  s_mov_b32 s57, 24
  s_lshl_b32 s85, s84, 9
  s_add_u32 s85, s85, 4096
  v_bfe_u32 v14, v0, 4, 2
  v_lshlrev_b32 v14, 1, v14
  v_and_b32 v15, 7, v0
  v_xor_b32 v14, v14, v15
  v_cmp_gt_u32 vcc, 4, v14
  v_mov_b32 v12, s62
  v_mov_b32 v15, s60
  v_cndmask_b32 v12, v12, v15, vcc
  v_mov_b32 v13, s63
  v_mov_b32 v15, s61
  v_cndmask_b32 v13, v13, v15, vcc
  s_mul_i32 s53, s56, 192
  v_lshrrev_b32 v15, 3, v0
  v_add_u32 v15, s53, v15
  v_mul_lo_u32 v15, v15, s59
  v_lshl_add_u32 v15, v14, 4, v15
  v_add_co_u32 v12, vcc, v12, v15
  s_nop 1
  v_addc_co_u32 v13, vcc, 0, v13, vcc
  s_mul_i32 s58, s56, 24576
  s_add_u32 s58, s58, 16384
  s_lshl_b32 s59, s59, 3
L_dma_98:
  s_mov_b32 m0, s58
  s_add_u32 s58, s58, 1024
  global_load_lds_dwordx4 v[12:13], off nt
  v_add_co_u32 v12, vcc, s59, v12
  s_nop 1
  v_addc_co_u32 v13, vcc, 0, v13, vcc
  s_waitcnt vmcnt(23)
  s_sub_u32 s57, s57, 1
  s_cmp_lg_u32 s57, 0
  s_cbranch_scc1 L_dma_98
  s_waitcnt vmcnt(0)
  ds_read_b64_tr_b16 v[72:73], v6 offset:0
  ds_read_b64_tr_b16 v[74:75], v6 offset:2048
  ds_read_b64_tr_b16 v[76:77], v7 offset:0
  ds_read_b64_tr_b16 v[78:79], v7 offset:2048
  ds_read_b64_tr_b16 v[80:81], v8 offset:0
  ds_read_b64_tr_b16 v[82:83], v8 offset:2048
  ds_read_b64_tr_b16 v[84:85], v9 offset:0
  ds_read_b64_tr_b16 v[86:87], v9 offset:2048
  ds_read_b64_tr_b16 v[88:89], v6 offset:4096
  ds_read_b64_tr_b16 v[90:91], v6 offset:6144
  ds_read_b64_tr_b16 v[92:93], v7 offset:4096
  ds_read_b64_tr_b16 v[94:95], v7 offset:6144
  ds_read_b64_tr_b16 v[96:97], v8 offset:4096
  ds_read_b64_tr_b16 v[98:99], v8 offset:6144
  ds_read_b64_tr_b16 v[100:101], v9 offset:4096
  ds_read_b64_tr_b16 v[102:103], v9 offset:6144
  ds_read_b64_tr_b16 v[104:105], v6 offset:8192
  ds_read_b64_tr_b16 v[106:107], v6 offset:10240
  ds_read_b64_tr_b16 v[108:109], v7 offset:8192
  ds_read_b64_tr_b16 v[110:111], v7 offset:10240
  ds_read_b64_tr_b16 v[112:113], v8 offset:8192
  ds_read_b64_tr_b16 v[114:115], v8 offset:10240
  ds_read_b64_tr_b16 v[116:117], v9 offset:8192
  ds_read_b64_tr_b16 v[118:119], v9 offset:10240
  ds_read_b64_tr_b16 v[120:121], v6 offset:12288
  ds_read_b64_tr_b16 v[122:123], v6 offset:14336
  ds_read_b64_tr_b16 v[124:125], v7 offset:12288
  ds_read_b64_tr_b16 v[126:127], v7 offset:14336
  ds_read_b64_tr_b16 v[128:129], v8 offset:12288
  ds_read_b64_tr_b16 v[130:131], v8 offset:14336
  ds_read_b64_tr_b16 v[132:133], v9 offset:12288
  ds_read_b64_tr_b16 v[134:135], v9 offset:14336
  ds_read_b64_tr_b16 v[136:137], v6 offset:16384
  ds_read_b64_tr_b16 v[138:139], v6 offset:18432
  ds_read_b64_tr_b16 v[140:141], v7 offset:16384
  ds_read_b64_tr_b16 v[142:143], v7 offset:18432
  ds_read_b64_tr_b16 v[144:145], v8 offset:16384
  ds_read_b64_tr_b16 v[146:147], v8 offset:18432
  ds_read_b64_tr_b16 v[148:149], v9 offset:16384
  ds_read_b64_tr_b16 v[150:151], v9 offset:18432
  ds_read_b64_tr_b16 v[152:153], v6 offset:20480
  ds_read_b64_tr_b16 v[154:155], v6 offset:22528
  ds_read_b64_tr_b16 v[156:157], v7 offset:20480
  ds_read_b64_tr_b16 v[158:159], v7 offset:22528
  ds_read_b64_tr_b16 v[160:161], v8 offset:20480
  ds_read_b64_tr_b16 v[162:163], v8 offset:22528
  ds_read_b64_tr_b16 v[164:165], v9 offset:20480
  ds_read_b64_tr_b16 v[166:167], v9 offset:22528
  v_and_b32 v17, 0xffff0000, v16
  v_lshlrev_b32 v16, 16, v16
  v_mul_f32 v24, 0xbfb8aa3b, v16
  s_mov_b32 s53, 0xbfb8aa3b
  v_fma_f32 v25, v16, s53, -v24
  s_mov_b32 s53, 0xb2a57060
  v_fma_f32 v25, v16, s53, v25
  v_exp_f32 v24, v24
  v_mul_f32 v25, 0x3f317218, v25
  v_min_f32 v24, 0x7e800000, v24
  v_fma_f32 v24, v24, v25, v24
  v_add_f32 v24, 1.0, v24
  v_rcp_f32 v25, v24
  s_nop 0
  v_mul_f32 v26, v16, v25
  v_fma_f32 v16, -v26, v24, v16
  v_fma_f32 v16, v16, v25, v26
  v_mul_f32 v24, 0xbfb8aa3b, v17
  s_mov_b32 s53, 0xbfb8aa3b
  v_fma_f32 v25, v17, s53, -v24
  s_mov_b32 s53, 0xb2a57060
  v_fma_f32 v25, v17, s53, v25
  v_exp_f32 v24, v24
  v_mul_f32 v25, 0x3f317218, v25
  v_min_f32 v24, 0x7e800000, v24
  v_fma_f32 v24, v24, v25, v24
  v_add_f32 v24, 1.0, v24
  v_rcp_f32 v25, v24
  s_nop 0
  v_mul_f32 v26, v17, v25
  v_fma_f32 v17, -v26, v24, v17
  v_fma_f32 v17, v17, v25, v26
  v_cvt_pk_bf16_f32 v14, v16, v17
  ds_write_b32 v4, v14 offset:0
  v_and_b32 v19, 0xffff0000, v18
  v_lshlrev_b32 v18, 16, v18
  v_mul_f32 v24, 0xbfb8aa3b, v18
  s_mov_b32 s53, 0xbfb8aa3b
  v_fma_f32 v25, v18, s53, -v24
  s_mov_b32 s53, 0xb2a57060
  v_fma_f32 v25, v18, s53, v25
  v_exp_f32 v24, v24
  v_mul_f32 v25, 0x3f317218, v25
  v_min_f32 v24, 0x7e800000, v24
  v_fma_f32 v24, v24, v25, v24
  v_add_f32 v24, 1.0, v24
  v_rcp_f32 v25, v24
  s_nop 0
  v_mul_f32 v26, v18, v25
  v_fma_f32 v18, -v26, v24, v18
  v_fma_f32 v18, v18, v25, v26
  v_mul_f32 v24, 0xbfb8aa3b, v19
  s_mov_b32 s53, 0xbfb8aa3b
  v_fma_f32 v25, v19, s53, -v24
  s_mov_b32 s53, 0xb2a57060
  v_fma_f32 v25, v19, s53, v25
  v_exp_f32 v24, v24
  v_mul_f32 v25, 0x3f317218, v25
  v_min_f32 v24, 0x7e800000, v24
  v_fma_f32 v24, v24, v25, v24
  v_add_f32 v24, 1.0, v24
  v_rcp_f32 v25, v24
  s_nop 0
  v_mul_f32 v26, v19, v25
  v_fma_f32 v19, -v26, v24, v19
  v_fma_f32 v19, v19, v25, v26
  v_cvt_pk_bf16_f32 v14, v18, v19
  ds_write_b32 v4, v14 offset:256
  v_and_b32 v21, 0xffff0000, v20
  v_lshlrev_b32 v20, 16, v20
  v_mul_f32 v24, 0xbfb8aa3b, v20
  s_mov_b32 s53, 0xbfb8aa3b
  v_fma_f32 v25, v20, s53, -v24
  s_mov_b32 s53, 0xb2a57060
  v_fma_f32 v25, v20, s53, v25
  v_exp_f32 v24, v24
  v_mul_f32 v25, 0x3f317218, v25
  v_min_f32 v24, 0x7e800000, v24
  v_fma_f32 v24, v24, v25, v24
  v_add_f32 v24, 1.0, v24
  v_rcp_f32 v25, v24
  s_nop 0
  v_mul_f32 v26, v20, v25
  v_fma_f32 v20, -v26, v24, v20
  v_fma_f32 v20, v20, v25, v26
  v_mul_f32 v24, 0xbfb8aa3b, v21
  s_mov_b32 s53, 0xbfb8aa3b
  v_fma_f32 v25, v21, s53, -v24
  s_mov_b32 s53, 0xb2a57060
  v_fma_f32 v25, v21, s53, v25
  v_exp_f32 v24, v24
  v_mul_f32 v25, 0x3f317218, v25
  v_min_f32 v24, 0x7e800000, v24
  v_fma_f32 v24, v24, v25, v24
  v_add_f32 v24, 1.0, v24
  v_rcp_f32 v25, v24
  s_nop 0
  v_mul_f32 v26, v21, v25
  v_fma_f32 v21, -v26, v24, v21
  v_fma_f32 v21, v21, v25, v26
  v_cvt_pk_bf16_f32 v14, v20, v21
  ds_write_b32 v4, v14 offset:512
  v_mov_b32 v14, 0
L_lw_99:
  ds_read_b32 v15, v14 offset:4
  s_waitcnt lgkmcnt(0)
  v_readfirstlane_b32 s53, v15
  s_nop 0
  s_cmp_eq_u32 s53, 1
  s_cbranch_scc1 L_lwd_100
  s_add_u32 s80, s80, 1
  s_cmp_gt_u32 s80, 4000000
  s_cbranch_scc1 L_exit
  s_sleep 1
  s_branch L_lw_99
L_lwd_100:
  ds_read_b32 v15, v14 offset:0
  s_waitcnt lgkmcnt(0)
  v_readfirstlane_b32 s52, v15
  ds_read_b128 v[16:19], v5 offset:0
  ds_read_b128 v[20:23], v5 offset:128
  ds_read_b128 v[24:27], v5 offset:256
  ds_read_b128 v[28:31], v5 offset:384
  ds_read_b128 v[32:35], v5 offset:512
  ds_read_b128 v[36:39], v5 offset:640
  s_waitcnt lgkmcnt(5)
  v_mfma_f32_16x16x32_bf16 v[40:43], v[16:19], v[72:75], 0
  v_mfma_f32_16x16x32_bf16 v[44:47], v[16:19], v[76:79], 0
  v_mfma_f32_16x16x32_bf16 v[48:51], v[16:19], v[80:83], 0
  v_mfma_f32_16x16x32_bf16 v[52:55], v[16:19], v[84:87], 0
  s_waitcnt lgkmcnt(4)
  v_mfma_f32_16x16x32_bf16 v[40:43], v[20:23], v[88:91], v[40:43]
  v_mfma_f32_16x16x32_bf16 v[44:47], v[20:23], v[92:95], v[44:47]
  v_mfma_f32_16x16x32_bf16 v[48:51], v[20:23], v[96:99], v[48:51]
  v_mfma_f32_16x16x32_bf16 v[52:55], v[20:23], v[100:103], v[52:55]
  s_waitcnt lgkmcnt(3)
  v_mfma_f32_16x16x32_bf16 v[40:43], v[24:27], v[104:107], v[40:43]
  v_mfma_f32_16x16x32_bf16 v[44:47], v[24:27], v[108:111], v[44:47]
  v_mfma_f32_16x16x32_bf16 v[48:51], v[24:27], v[112:115], v[48:51]
  v_mfma_f32_16x16x32_bf16 v[52:55], v[24:27], v[116:119], v[52:55]
  s_waitcnt lgkmcnt(2)
  v_mfma_f32_16x16x32_bf16 v[40:43], v[28:31], v[120:123], v[40:43]
  v_mfma_f32_16x16x32_bf16 v[44:47], v[28:31], v[124:127], v[44:47]
  v_mfma_f32_16x16x32_bf16 v[48:51], v[28:31], v[128:131], v[48:51]
  v_mfma_f32_16x16x32_bf16 v[52:55], v[28:31], v[132:135], v[52:55]
  s_waitcnt lgkmcnt(1)
  v_mfma_f32_16x16x32_bf16 v[40:43], v[32:35], v[136:139], v[40:43]
  v_mfma_f32_16x16x32_bf16 v[44:47], v[32:35], v[140:143], v[44:47]
  v_mfma_f32_16x16x32_bf16 v[48:51], v[32:35], v[144:147], v[48:51]
  v_mfma_f32_16x16x32_bf16 v[52:55], v[32:35], v[148:151], v[52:55]
  s_waitcnt lgkmcnt(0)
  v_mfma_f32_16x16x32_bf16 v[40:43], v[36:39], v[152:155], v[40:43]
  v_mfma_f32_16x16x32_bf16 v[44:47], v[36:39], v[156:159], v[44:47]
  v_mfma_f32_16x16x32_bf16 v[48:51], v[36:39], v[160:163], v[48:51]
  v_mfma_f32_16x16x32_bf16 v[52:55], v[36:39], v[164:167], v[52:55]
  s_nop 5
  v_mov_b32_dpp v40, v44 quad_perm:[0,1,2,3] row_mask:0x2 bank_mask:0xf
  v_mov_b32_dpp v41, v45 quad_perm:[0,1,2,3] row_mask:0x2 bank_mask:0xf
  s_nop 0
  v_mov_b32_dpp v40, v48 quad_perm:[0,1,2,3] row_mask:0x4 bank_mask:0xf
  v_mov_b32_dpp v41, v49 quad_perm:[0,1,2,3] row_mask:0x4 bank_mask:0xf
  s_nop 0
  v_mov_b32_dpp v40, v52 quad_perm:[0,1,2,3] row_mask:0x8 bank_mask:0xf
  v_mov_b32_dpp v41, v53 quad_perm:[0,1,2,3] row_mask:0x8 bank_mask:0xf
  s_lshl_b32 s53, s56, 9
  v_add_u32 v14, s53, v10
  ds_write_b64 v14, v[40:41] offset:4096
  v_mov_b32 v14, 0
  v_mov_b32 v15, 1
  s_mov_b64 exec, 1
  ds_add_rtn_u32 v15, v14, v15 offset:44
  s_mov_b64 exec, -1
  s_waitcnt lgkmcnt(0)
  v_readfirstlane_b32 s53, v15
  s_nop 0
  s_cmp_eq_u32 s53, 2
  s_cbranch_scc0 L_t_done
  ds_read_b128 v[40:43], v1 offset:4096
  ds_read_b128 v[44:47], v1 offset:4608
  ds_read_b128 v[48:51], v1 offset:5120
  s_waitcnt lgkmcnt(0)
  v_add_f32 v40, v40, v44
  v_add_f32 v41, v41, v45
  v_add_f32 v42, v42, v46
  v_add_f32 v43, v43, v47
  v_add_f32 v40, v40, v48
  v_add_f32 v41, v41, v49
  v_add_f32 v42, v42, v50
  v_add_f32 v43, v43, v51
  v_cvt_pk_bf16_f32 v40, v40, v41
  v_cvt_pk_bf16_f32 v42, v42, v43
  v_mov_b32 v41, s52
  v_mov_b32 v43, s52
  s_mov_b32 exec_hi, 0
  buffer_store_dwordx4 v[40:43], v1, s[16:19], s85 offen sc1
  s_mov_b64 exec, -1
  s_branch L_t_done
L_f_wo:
  s_mul_i32 s53, s4, 589824
  s_lshl_b32 s54, s5, 7
  s_add_u32 s53, s53, s54
  s_add_u32 s60, s32, s53
  s_addc_u32 s61, s33, 0
  s_mov_b32 s62, s60
  s_mov_b32 s63, s61
  s_mov_b32 s59, 1152
  s_cmp_eq_u32 s56, 2
  s_cselect_b32 s57, 16, 24
  v_bfe_u32 v14, v0, 4, 2
  v_lshlrev_b32 v14, 1, v14
  v_and_b32 v15, 7, v0
  v_xor_b32 v14, v14, v15
  v_cmp_gt_u32 vcc, 4, v14
  v_mov_b32 v12, s62
  v_mov_b32 v15, s60
  v_cndmask_b32 v12, v12, v15, vcc
  v_mov_b32 v13, s63
  v_mov_b32 v15, s61
  v_cndmask_b32 v13, v13, v15, vcc
  s_mul_i32 s53, s56, 192
  v_lshrrev_b32 v15, 3, v0
  v_add_u32 v15, s53, v15
  v_mul_lo_u32 v15, v15, s59
  v_lshl_add_u32 v15, v14, 4, v15
  v_add_co_u32 v12, vcc, v12, v15
  s_nop 1
  v_addc_co_u32 v13, vcc, 0, v13, vcc
  s_mul_i32 s58, s56, 24576
  s_add_u32 s58, s58, 16384
  s_lshl_b32 s59, s59, 3
L_dma_101:
  s_mov_b32 m0, s58
  s_add_u32 s58, s58, 1024
  global_load_lds_dwordx4 v[12:13], off nt
  v_add_co_u32 v12, vcc, s59, v12
  s_nop 1
  v_addc_co_u32 v13, vcc, 0, v13, vcc
  s_waitcnt vmcnt(23)
  s_sub_u32 s57, s57, 1
  s_cmp_lg_u32 s57, 0
  s_cbranch_scc1 L_dma_101
  s_branch L_t_done
L_f_done:
  s_cmp_eq_u32 s3, 8
  s_cbranch_scc1 L_par
  s_sub_u32 s86, s3, 9
  s_mul_i32 s84, s4, 18
  s_add_u32 s84, s84, s5
  s_sub_u32 s84, s84, 9
  s_cmp_eq_u32 s86, 0
  s_cselect_b32 s20, s36, s38
  s_cselect_b32 s21, s37, s39
  s_mov_b32 s22, 5308416
  s_mov_b32 s23, 0x20000
  v_bfe_u32 v16, v0, 4, 2
  v_lshlrev_b32 v16, 1, v16
  v_and_b32 v17, 7, v0
  v_xor_b32 v16, v16, v17
  v_lshrrev_b32 v17, 3, v0
  v_mul_u32_u24 v17, 9216, v17
  v_lshl_add_u32 v16, v16, 4, v17
  s_and_b32 s62, s84, 1
  s_mul_i32 s62, s62, 294912
  s_lshr_b32 s53, s84, 1
  s_lshl_b32 s53, s53, 7
  s_add_u32 s62, s62, s53
  s_mul_i32 s63, s86, 36864
  s_add_u32 s63, s63, 16384
  s_mov_b32 s85, 0
  s_cmp_lt_u32 s83, 3
  s_cbranch_scc0 L_nfc
  v_mov_b32 v14, 0
L_lw_102:
  ds_read_b32 v15, v14 offset:44
  s_waitcnt lgkmcnt(0)
  v_readfirstlane_b32 s53, v15
  s_nop 0
  s_cmp_eq_u32 s53, 3
  s_cbranch_scc1 L_lwd_103
  s_add_u32 s80, s80, 1
  s_cmp_gt_u32 s80, 4000000
  s_cbranch_scc1 L_exit
  s_sleep 1
  s_branch L_lw_102
L_lwd_103:
L_nfc:
  s_mov_b32 s57, 0
  s_bfe_u32 s53, s84, 0x30001
  s_cmp_eq_u32 s53, 3
  s_cselect_b32 s57, 8, s57
  s_cmp_eq_u32 s57, 0
  s_cbranch_scc1 L_w13_104_e
L_w13_104:
  s_mov_b32 m0, s63
  s_add_u32 s63, s63, 1024
  buffer_load_dwordx4 v16, s[20:23], s62 offen nt lds
  s_add_u32 s85, s85, 1
  s_and_b32 s53, s85, 3
  s_cselect_b32 s53, 0, 294912
  s_add_u32 s62, s62, s53
  s_add_u32 s62, s62, 73728
  s_waitcnt vmcnt(1)
  s_sub_u32 s57, s57, 1
  s_cmp_lg_u32 s57, 0
  s_cbranch_scc1 L_w13_104
L_w13_104_e:
  v_mov_b32 v14, 0
L_lw_105:
  ds_read_b32 v15, v14 offset:36
  s_waitcnt lgkmcnt(0)
  v_readfirstlane_b32 s53, v15
  s_nop 0
  s_cmp_ge_u32 s53, 60
  s_cbranch_scc1 L_lwd_106
  s_add_u32 s80, s80, 1
  s_cmp_gt_u32 s80, 4000000
  s_cbranch_scc1 L_exit
  s_sleep 4
  s_branch L_lw_105
L_lwd_106:
  v_mov_b32 v14, 0
L_lw_107:
  ds_read_b32 v15, v14 offset:28
  s_waitcnt lgkmcnt(0)
  v_readfirstlane_b32 s53, v15
  s_nop 0
  s_cmp_ge_u32 s53, 8
  s_cbranch_scc1 L_lwd_108
  s_add_u32 s80, s80, 1
  s_cmp_gt_u32 s80, 4000000
  s_cbranch_scc1 L_exit
  s_branch L_lw_107
L_lwd_108:
  s_setprio 2
  s_mov_b32 s7, 0
  s_mov_b32 s57, 12
  s_bfe_u32 s53, s84, 0x30001
  s_cmp_eq_u32 s53, 3
  s_cselect_b32 s57, 12, s57
  s_cmp_eq_u32 s57, 0
  s_cbranch_scc1 L_w13_109_e
L_w13_109:
  s_mov_b32 m0, s63
  s_add_u32 s63, s63, 1024
  buffer_load_dwordx4 v16, s[20:23], s62 offen nt lds
  s_add_u32 s85, s85, 1
  s_and_b32 s53, s85, 3
  s_cselect_b32 s53, 0, 294912
  s_add_u32 s62, s62, s53
  s_add_u32 s62, s62, 73728
  s_waitcnt vmcnt(39)
  s_sub_u32 s57, s57, 1
  s_cmp_lg_u32 s57, 0
  s_cbranch_scc1 L_w13_109
L_w13_109_e:
  v_mov_b32 v14, 0
L_lw_110:
  ds_read_b32 v15, v14 offset:32
  s_waitcnt lgkmcnt(0)
  v_readfirstlane_b32 s53, v15
  s_nop 0
  s_cmp_eq_u32 s53, 1
  s_cbranch_scc1 L_lwd_111
  s_add_u32 s80, s80, 1
  s_cmp_gt_u32 s80, 4000000
  s_cbranch_scc1 L_exit
  s_branch L_lw_110
L_lwd_111:
  s_mov_b32 s57, 24
  s_bfe_u32 s53, s84, 0x30001
  s_cmp_eq_u32 s53, 3
  s_cselect_b32 s57, 16, s57
  s_cmp_eq_u32 s57, 0
  s_cbranch_scc1 L_w13_112_e
L_w13_112:
  s_mov_b32 m0, s63
  s_add_u32 s63, s63, 1024
  buffer_load_dwordx4 v16, s[20:23], s62 offen nt lds
  s_add_u32 s85, s85, 1
  s_and_b32 s53, s85, 3
  s_cselect_b32 s53, 0, 294912
  s_add_u32 s62, s62, s53
  s_add_u32 s62, s62, 73728
  s_waitcnt vmcnt(14)
  s_sub_u32 s57, s57, 1
  s_cmp_lg_u32 s57, 0
  s_cbranch_scc1 L_w13_112
L_w13_112_e:
  s_mul_i32 s53, s84, 36864
  s_mul_i32 s58, s86, 18432
  s_add_u32 s53, s53, s58
  s_add_u32 s60, s40, s53
  s_addc_u32 s61, s41, 0
  v_lshlrev_b32 v12, 4, v0
  v_mov_b32 v13, s61
  v_add_co_u32 v12, vcc, s60, v12
  s_nop 1
  v_addc_co_u32 v13, vcc, 0, v13, vcc
  s_add_u32 s58, s58, 90112
  s_mov_b32 s57, 14
  s_movk_i32 s59, 1024
L_dma_113:
  s_mov_b32 m0, s58
  s_add_u32 s58, s58, 1024
  global_load_lds_dwordx4 v[12:13], off nt
  v_add_co_u32 v12, vcc, s59, v12
  s_nop 1
  v_addc_co_u32 v13, vcc, 0, v13, vcc
  s_waitcnt vmcnt(14)
  s_sub_u32 s57, s57, 1
  s_cmp_lg_u32 s57, 0
  s_cbranch_scc1 L_dma_113
  s_waitcnt vmcnt(14)
  v_mov_b32 v14, 0
  v_mov_b32 v15, 1
  s_mov_b64 exec, 1
  ds_add_u32 v14, v15 offset:24
  s_mov_b64 exec, -1
  s_mov_b32 s57, 4
L_dma_114:
  s_mov_b32 m0, s58
  s_add_u32 s58, s58, 1024
  global_load_lds_dwordx4 v[12:13], off nt
  v_add_co_u32 v12, vcc, s59, v12
  s_nop 1
  v_addc_co_u32 v13, vcc, 0, v13, vcc
  s_waitcnt vmcnt(14)
  s_sub_u32 s57, s57, 1
  s_cmp_lg_u32 s57, 0
  s_cbranch_scc1 L_dma_114
  s_waitcnt vmcnt(0)
  v_mov_b32 v14, 0
  v_mov_b32 v15, 1
  s_mov_b64 exec, 1
  ds_add_u32 v14, v15 offset:52
  s_mov_b64 exec, -1
  s_branch L_exit
L_par:
  v_mov_b32 v14, 0
L_lw_115:
  ds_read_b32 v15, v14 offset:4
  s_waitcnt lgkmcnt(0)
  v_readfirstlane_b32 s53, v15
  s_nop 0
  s_cmp_eq_u32 s53, 1
  s_cbranch_scc1 L_lwd_116
  s_add_u32 s80, s80, 1
  s_cmp_gt_u32 s80, 4000000
  s_cbranch_scc1 L_exit
  s_sleep 1
  s_branch L_lw_115
L_lwd_116:
  ds_read_b32 v15, v14 offset:0
  s_waitcnt lgkmcnt(0)
  v_readfirstlane_b32 s52, v15
  s_nop 0
  s_and_b32 s87, s52, 0xff
  s_mul_i32 s88, s87, 0x01010101
  s_xor_b32 s88, s88, 0xe19c3500
  v_mov_b32 v11, s88
  s_mov_b32 s89, 0
  s_mov_b32 s26, 0x7060500
  s_bfe_u32 s30, s88, 0x80000
  s_mov_b32 s27, 0x7060501
  s_bfe_u32 s31, s88, 0x80008
  s_mov_b32 s28, 0x7060502
  s_bfe_u32 s32, s88, 0x80010
  s_mov_b32 s29, 0x7060503
  s_bfe_u32 s33, s88, 0x80018
  s_and_b32 s54, s5, 1
  s_xor_b32 s54, s54, 1
  s_mul_i32 s55, s54, 1344
  s_add_u32 s55, s55, 126976
  v_lshrrev_b32 v14, 5, v0
  v_mul_u32_u24 v12, 0, v14
  v_lshrrev_b32 v14, 4, v0
  v_mul_u32_u24 v14, 2688, v14
  v_add_u32 v12, v14, v12
  v_bfe_u32 v14, v0, 1, 2
  v_lshl_add_u32 v12, v14, 4, v12
  v_bfe_u32 v14, v0, 3, 1
  v_lshl_add_u32 v12, v14, 3, v12
  v_and_b32 v14, 1, v0
  v_lshl_add_u32 v12, v14, 2, v12
  v_add_u32 v12, s55, v12
  v_and_b32 v16, 15, v0
  v_lshlrev_b32 v16, 4, v16
  v_lshrrev_b32 v17, 4, v0
  v_lshl_add_u32 v16, v17, 9, v16
  s_lshl_b32 s54, s54, 8
  v_add_u32 v16, s54, v16
  s_mov_b32 s62, 0x05040100
  s_mov_b32 s63, 0x07060302
  v_mov_b32 v14, 0
L_lw_117:
  ds_read_b32 v15, v14 offset:36
  s_waitcnt lgkmcnt(0)
  v_readfirstlane_b32 s53, v15
  s_nop 0
  s_cmp_ge_u32 s53, 54
  s_cbranch_scc1 L_lwd_118
  s_add_u32 s80, s80, 1
  s_cmp_gt_u32 s80, 4000000
  s_cbranch_scc1 L_exit
  s_sleep 4
  s_branch L_lw_117
L_lwd_118:
L_parp:
  s_mov_b32 s60, 17920
  s_mov_b32 s61, 22016
  buffer_load_dwordx4 v[32:35], v16, s[16:19], s60 offen offset:0 sc1
  buffer_load_dwordx4 v[36:39], v16, s[16:19], s60 offen offset:2048 sc1
  s_mov_b64 exec, 0xffff
  buffer_load_dwordx4 v[40:43], v16, s[16:19], s61 offen offset:0 sc1
  s_mov_b64 exec, -1
  s_mov_b32 s60, 22528
  s_mov_b32 s61, 26624
  buffer_load_dwordx4 v[44:47], v16, s[16:19], s60 offen offset:0 sc1
  buffer_load_dwordx4 v[48:51], v16, s[16:19], s60 offen offset:2048 sc1
  s_mov_b64 exec, 0xffff
  buffer_load_dwordx4 v[52:55], v16, s[16:19], s61 offen offset:0 sc1
  s_mov_b64 exec, -1
  s_add_u32 s80, s80, 1
  s_cmp_gt_u32 s80, 4000000
  s_cbranch_scc1 L_exit
  v_mov_b32 v14, 0
  s_waitcnt vmcnt(0)
  v_xor_b32 v15, s52, v33
  v_xor_b32 v19, s52, v35
  v_or3_b32 v14, v14, v15, v19
  v_xor_b32 v15, s52, v37
  v_xor_b32 v19, s52, v39
  v_or3_b32 v14, v14, v15, v19
  s_mov_b64 exec, 0xffff
  v_xor_b32 v15, s52, v41
  v_xor_b32 v19, s52, v43
  v_or3_b32 v14, v14, v15, v19
  s_mov_b64 exec, -1
  v_xor_b32 v15, s52, v45
  v_xor_b32 v19, s52, v47
  v_or3_b32 v14, v14, v15, v19
  v_xor_b32 v15, s52, v49
  v_xor_b32 v19, s52, v51
  v_or3_b32 v14, v14, v15, v19
  s_mov_b64 exec, 0xffff
  v_xor_b32 v15, s52, v53
  v_xor_b32 v19, s52, v55
  v_or3_b32 v14, v14, v15, v19
  s_mov_b64 exec, -1
  v_cmp_ne_u32 vcc, 0, v14
  s_cbranch_vccz L_pard
  s_sleep 8
  s_branch L_parp
L_pard:
  v_perm_b32 v14, v34, v32, s62
  ds_write_b32 v12, v14 offset:320
  v_perm_b32 v14, v46, v44, s62
  v_and_b32 v15, 0xffff0000, v14
  v_lshlrev_b32 v14, 16, v14
  v_add_f32 v14, 1.0, v14
  v_add_f32 v15, 1.0, v15
  v_cvt_pk_bf16_f32 v14, v14, v15
  ds_write_b32 v12, v14 offset:160
  v_perm_b32 v14, v34, v32, s63
  ds_write_b32 v12, v14 offset:400
  v_perm_b32 v14, v46, v44, s63
  v_and_b32 v15, 0xffff0000, v14
  v_lshlrev_b32 v14, 16, v14
  v_add_f32 v14, 1.0, v14
  v_add_f32 v15, 1.0, v15
  v_cvt_pk_bf16_f32 v14, v14, v15
  ds_write_b32 v12, v14 offset:240
  v_perm_b32 v14, v38, v36, s62
  ds_write_b32 v12, v14 offset:11072
  v_perm_b32 v14, v50, v48, s62
  v_and_b32 v15, 0xffff0000, v14
  v_lshlrev_b32 v14, 16, v14
  v_add_f32 v14, 1.0, v14
  v_add_f32 v15, 1.0, v15
  v_cvt_pk_bf16_f32 v14, v14, v15
  ds_write_b32 v12, v14 offset:10912
  v_perm_b32 v14, v38, v36, s63
  ds_write_b32 v12, v14 offset:11152
  v_perm_b32 v14, v50, v48, s63
  v_and_b32 v15, 0xffff0000, v14
  v_lshlrev_b32 v14, 16, v14
  v_add_f32 v14, 1.0, v14
  v_add_f32 v15, 1.0, v15
  v_cvt_pk_bf16_f32 v14, v14, v15
  ds_write_b32 v12, v14 offset:10992
  s_mov_b64 exec, 0xffff
  v_perm_b32 v14, v42, v40, s62
  ds_write_b32 v12, v14 offset:21824
  v_perm_b32 v14, v54, v52, s62
  v_and_b32 v15, 0xffff0000, v14
  v_lshlrev_b32 v14, 16, v14
  v_add_f32 v14, 1.0, v14
  v_add_f32 v15, 1.0, v15
  v_cvt_pk_bf16_f32 v14, v14, v15
  ds_write_b32 v12, v14 offset:21664
  v_perm_b32 v14, v42, v40, s63
  ds_write_b32 v12, v14 offset:21904
  v_perm_b32 v14, v54, v52, s63
  v_and_b32 v15, 0xffff0000, v14
  v_lshlrev_b32 v14, 16, v14
  v_add_f32 v14, 1.0, v14
  v_add_f32 v15, 1.0, v15
  v_cvt_pk_bf16_f32 v14, v14, v15
  ds_write_b32 v12, v14 offset:21744
  s_mov_b64 exec, -1
  v_mov_b32 v14, 0
L_lw_119:
  ds_read_b32 v15, v14 offset:36
  s_waitcnt lgkmcnt(0)
  v_readfirstlane_b32 s53, v15
  s_nop 0
  s_cmp_ge_u32 s53, 60
  s_cbranch_scc1 L_lwd_120
  s_add_u32 s80, s80, 1
  s_cmp_gt_u32 s80, 4000000
  s_cbranch_scc1 L_exit
  s_sleep 4
  s_branch L_lw_119
L_lwd_120:
  v_mov_b32 v14, 0
  v_mov_b32 v15, 1
  s_mov_b64 exec, 1
  ds_add_u32 v14, v15 offset:48
  s_mov_b64 exec, -1
  s_branch L_tail
L_t_done:
  s_waitcnt vmcnt(0)
  v_mov_b32 v14, 0
  v_mov_b32 v15, 1
  s_mov_b64 exec, 1
  ds_add_u32 v14, v15 offset:24
  s_mov_b64 exec, -1
  s_cmp_eq_u32 s3, 10
  s_cbranch_scc1 L_exit
  s_cmp_lt_u32 s5, 9
  s_cbranch_scc1 L_wow
  v_mov_b32 v14, 0
L_lw_121:
  ds_read_b32 v15, v14 offset:32
  s_waitcnt lgkmcnt(0)
  v_readfirstlane_b32 s53, v15
  s_nop 0
  s_cmp_eq_u32 s53, 1
  s_cbranch_scc1 L_lwd_122
  s_add_u32 s80, s80, 1
  s_cmp_gt_u32 s80, 4000000
  s_cbranch_scc1 L_exit
  s_sleep 4
  s_branch L_lw_121
L_lwd_122:
  s_branch L_tail
L_wow:
  v_mov_b32 v14, 0
L_lw_123:
  ds_read_b32 v15, v14 offset:4
  s_waitcnt lgkmcnt(0)
  v_readfirstlane_b32 s53, v15
  s_nop 0
  s_cmp_eq_u32 s53, 1
  s_cbranch_scc1 L_lwd_124
  s_add_u32 s80, s80, 1
  s_cmp_gt_u32 s80, 4000000
  s_cbranch_scc1 L_exit
  s_sleep 1
  s_branch L_lw_123
L_lwd_124:
  ds_read_b32 v15, v14 offset:0
  s_waitcnt lgkmcnt(0)
  v_readfirstlane_b32 s52, v15
  s_nop 0
  s_and_b32 s87, s52, 0xff
  s_mul_i32 s88, s87, 0x01010101
  s_xor_b32 s88, s88, 0xe19c3500
  v_mov_b32 v11, s88
  s_mov_b32 s89, 0
  s_mov_b32 s26, 0x7060500
  s_bfe_u32 s30, s88, 0x80000
  s_mov_b32 s27, 0x7060501
  s_bfe_u32 s31, s88, 0x80008
  s_mov_b32 s28, 0x7060502
  s_bfe_u32 s32, s88, 0x80010
  s_mov_b32 s29, 0x7060503
  s_bfe_u32 s33, s88, 0x80018
  s_cmp_ge_u32 s3, 9
  s_cbranch_scc1 L_wox
  v_mov_b32 v14, 0
L_lw_125:
  ds_read_b32 v15, v14 offset:24
  s_waitcnt lgkmcnt(0)
  v_readfirstlane_b32 s53, v15
  s_nop 0
  s_cmp_eq_u32 s53, 3
  s_cbranch_scc1 L_lwd_126
  s_add_u32 s80, s80, 1
  s_cmp_gt_u32 s80, 4000000
  s_cbranch_scc1 L_exit
  s_sleep 4
  s_branch L_lw_125
L_lwd_126:
  v_mov_b32 v14, 0
L_lw_127:
  ds_read_b32 v15, v14 offset:36
  s_waitcnt lgkmcnt(0)
  v_readfirstlane_b32 s53, v15
  s_nop 0
  s_cmp_ge_u32 s53, 60
  s_cbranch_scc1 L_lwd_128
  s_add_u32 s80, s80, 1
  s_cmp_gt_u32 s80, 4000000
  s_cbranch_scc1 L_exit
  s_sleep 4
  s_branch L_lw_127
L_lwd_128:
  s_lshl_b32 s60, s4, 14
  s_add_u32 s60, s60, 131072
  v_mov_b32 v14, 0
  v_mov_b32 v15, 1
  s_mov_b64 exec, 1
  ds_add_u32 v14, v15 offset:48
  s_mov_b64 exec, -1
  s_barrier
  s_branch L_exit
L_wox:
  s_mov_b32 s20, s24
  s_mov_b32 s21, s25
  s_mov_b32 s22, 2304
  s_mov_b32 s23, 0x20000
  v_mov_b32 v14, 0
L_lw_129:
  ds_read_b32 v15, v14 offset:36
  s_waitcnt lgkmcnt(0)
  v_readfirstlane_b32 s53, v15
  s_nop 0
  s_cmp_ge_u32 s53, 54
  s_cbranch_scc1 L_lwd_130
  s_add_u32 s80, s80, 1
  s_cmp_gt_u32 s80, 4000000
  s_cbranch_scc1 L_exit
  s_sleep 4
  s_branch L_lw_129
L_lwd_130:
  v_mov_b32 v14, 0
L_lw_131:
  ds_read_b32 v15, v14 offset:56
  s_waitcnt lgkmcnt(0)
  v_readfirstlane_b32 s53, v15
  s_nop 0
  s_cmp_ge_u32 s53, 1
  s_cbranch_scc1 L_lwd_132
  s_add_u32 s80, s80, 1
  s_cmp_gt_u32 s80, 4000000
  s_cbranch_scc1 L_exit
  s_sleep 1
  s_branch L_lw_131
L_lwd_132:
  s_mov_b32 s81, s53
  s_lshl_b32 s53, s5, 7
  buffer_load_dword v16, v2, s[20:23], s53 offen
  s_lshl_b32 s60, s5, 9
  s_add_u32 s60, s60, 13312
  buffer_load_dwordx4 v[20:23], v1, s[16:19], s60 offen sc1
  s_branch L_polle_135
L_poll_133:
  s_mov_b64 exec, s[64:65]
  buffer_load_dwordx4 v[20:23], v1, s[16:19], s60 offen sc1
  s_mov_b64 exec, -1
  s_add_u32 s80, s80, 1
  s_cmp_gt_u32 s80, 4000000
  s_cbranch_scc1 L_exit
L_polle_135:
  s_waitcnt vmcnt(0)
  v_xor_b32 v14, s52, v21
  v_xor_b32 v15, s52, v23
  v_or_b32 v14, v14, v15
  v_cmp_ne_u32 s[64:65], 0, v14
  s_nop 0
  s_cmp_lg_u64 s[64:65], 0
  s_cbranch_scc0 L_polld_134
  s_sleep 2
  s_branch L_poll_133
L_polld_134:
  v_perm_b32 v20, v20, v20, v3
  v_perm_b32 v21, v22, v22, v3
  v_and_b32 v17, 0xffff0000, v16
  v_lshlrev_b32 v16, 16, v16
  v_lshlrev_b32 v18, 4, v0
  s_lshl_b32 s60, s5, 12
  s_add_u32 s60, s60, 393216
  s_mul_i32 s61, s4, 5120
  s_lshl_b32 s53, s5, 9
  s_add_u32 s61, s61, s53
  s_add_u32 s61, s61, 1130496
  s_barrier
  buffer_load_dwordx4 v[40:43], v18, s[16:19], s60 offen offset:0 sc1
  buffer_load_dwordx4 v[44:47], v18, s[16:19], s60 offen offset:1024 sc1
  buffer_load_dwordx4 v[48:51], v18, s[16:19], s60 offen offset:2048 sc1
  buffer_load_dwordx4 v[52:55], v18, s[16:19], s60 offen offset:3072 sc1
  s_mov_b64 s[64:65], -1
  s_mov_b64 s[66:67], -1
  s_mov_b64 s[68:69], -1
  s_mov_b64 s[70:71], -1
  s_branch L_polle_138
L_poll_136:
  s_mov_b64 exec, s[64:65]
  buffer_load_dwordx4 v[40:43], v18, s[16:19], s60 offen offset:0 sc1
  s_mov_b64 exec, s[66:67]
  buffer_load_dwordx4 v[44:47], v18, s[16:19], s60 offen offset:1024 sc1
  s_mov_b64 exec, s[68:69]
  buffer_load_dwordx4 v[48:51], v18, s[16:19], s60 offen offset:2048 sc1
  s_mov_b64 exec, s[70:71]
  buffer_load_dwordx4 v[52:55], v18, s[16:19], s60 offen offset:3072 sc1
  s_mov_b64 exec, -1
  s_add_u32 s80, s80, 1
  s_cmp_gt_u32 s80, 4000000
  s_cbranch_scc1 L_exit
L_polle_138:
  s_mov_b64 exec, s[64:65]
  s_cbranch_execz L_sk_139
  s_waitcnt vmcnt(3)
  v_xor_b32 v40, s30, v40
  v_xor_b32 v41, s31, v41
  v_xor_b32 v42, s32, v42
  v_xor_b32 v43, s33, v43
  v_or3_b32 v14, v40, v41, v42
  v_or_b32 v14, v14, v43
  v_cmp_ne_u32_sdwa s[64:65], v14, s89 src0_sel:BYTE_0 src1_sel:DWORD
  s_nop 0
  s_wqm_b64 s[64:65], s[64:65]
L_sk_139:
  s_mov_b64 exec, s[66:67]
  s_cbranch_execz L_sk_140
  s_waitcnt vmcnt(2)
  v_xor_b32 v44, s30, v44
  v_xor_b32 v45, s31, v45
  v_xor_b32 v46, s32, v46
  v_xor_b32 v47, s33, v47
  v_or3_b32 v14, v44, v45, v46
  v_or_b32 v14, v14, v47
  v_cmp_ne_u32_sdwa s[66:67], v14, s89 src0_sel:BYTE_0 src1_sel:DWORD
  s_nop 0
  s_wqm_b64 s[66:67], s[66:67]
L_sk_140:
  s_mov_b64 exec, s[68:69]
  s_cbranch_execz L_sk_141
  s_waitcnt vmcnt(1)
  v_xor_b32 v48, s30, v48
  v_xor_b32 v49, s31, v49
  v_xor_b32 v50, s32, v50
  v_xor_b32 v51, s33, v51
  v_or3_b32 v14, v48, v49, v50
  v_or_b32 v14, v14, v51
  v_cmp_ne_u32_sdwa s[68:69], v14, s89 src0_sel:BYTE_0 src1_sel:DWORD
  s_nop 0
  s_wqm_b64 s[68:69], s[68:69]
L_sk_141:
  s_mov_b64 exec, s[70:71]
  s_cbranch_execz L_sk_142
  s_waitcnt vmcnt(0)
  v_xor_b32 v52, s30, v52
  v_xor_b32 v53, s31, v53
  v_xor_b32 v54, s32, v54
  v_xor_b32 v55, s33, v55
  v_or3_b32 v14, v52, v53, v54
  v_or_b32 v14, v14, v55
  v_cmp_ne_u32_sdwa s[70:71], v14, s89 src0_sel:BYTE_0 src1_sel:DWORD
  s_nop 0
  s_wqm_b64 s[70:71], s[70:71]
L_sk_142:
  s_mov_b64 exec, -1
  s_or_b64 s[54:55], s[64:65], s[66:67]
  s_or_b64 s[54:55], s[54:55], s[68:69]
  s_or_b64 s[54:55], s[54:55], s[70:71]
  s_cbranch_scc1 L_poll_136
  v_pk_add_f32 v[40:41], v[40:41], v[44:45]
  v_pk_add_f32 v[42:43], v[42:43], v[46:47]
  v_pk_add_f32 v[48:49], v[48:49], v[52:53]
  v_pk_add_f32 v[50:51], v[50:51], v[54:55]
  v_pk_add_f32 v[40:41], v[40:41], v[48:49]
  v_pk_add_f32 v[42:43], v[42:43], v[50:51]
  s_nop 0
  v_permlane32_swap_b32 v40, v41
  v_permlane32_swap_b32 v42, v43
  v_add_f32 v40, v40, v41
  v_add_f32 v41, v42, v43
  v_cvt_pk_bf16_f32 v14, v40, v41
  v_lshlrev_b32 v40, 16, v14
  v_and_b32 v41, 0xffff0000, v14
  v_pk_mul_f32 v[40:41], v[40:41], v[20:21]
  v_cvt_pk_bf16_f32 v14, v40, v41
  v_lshlrev_b32 v40, 16, v14
  v_and_b32 v41, 0xffff0000, v14
  v_pk_add_f32 v[40:41], v[40:41], v[16:17]
  v_mov_b32 v43, s52
  v_cvt_pk_bf16_f32 v42, v40, v41
  s_cmp_eq_u32 s81, 1
  s_cbranch_scc0 L_ls_143
  buffer_store_dwordx2 v[42:43], v10, s[16:19], s61 offen
  s_branch L_lsd_144
L_ls_143:
  buffer_store_dwordx2 v[42:43], v10, s[16:19], s61 offen sc1
L_lsd_144:
  s_branch L_exit
L_H3:
  s_mov_b32 s80, 0
  s_setprio 3
  s_mov_b32 s16, s50
  s_mov_b32 s17, s51
  s_mov_b32 s18, 268435456
  s_mov_b32 s19, 0x20000
  v_lshlrev_b32 v1, 2, v0
  v_mov_b32 v2, 0
  v_lshlrev_b32 v9, 4, v0
  s_load_dword s58, s[50:51], 0
  s_lshl_b32 s82, s6, 10
  s_add_u32 s82, s82, 131072
  s_and_b32 s60, s82, 0xffffe000
  s_add_u32 s61, s60, 2048
  s_add_u32 s62, s60, 4096
  s_waitcnt lgkmcnt(0)
  s_mov_b32 s53, s58
  s_mul_i32 s52, s53, 1664525
  s_add_u32 s52, s52, 1013904223
  s_and_b32 s52, s52, 0xffffff00
  s_add_u32 s53, s53, 1
  s_and_b32 s53, s53, 0xff
  s_or_b32 s52, s52, s53
  v_mov_b32 v4, s52
  v_mov_b32 v5, 1
  ds_write_b64 v2, v[4:5] offset:0
  s_and_b32 s87, s52, 0xff
  s_mul_i32 s88, s87, 0x01010101
  s_xor_b32 s88, s88, 0xe19c3500
  v_mov_b32 v11, s88
  s_mov_b32 s89, 0
  s_mov_b32 s26, 0x7060500
  s_bfe_u32 s30, s88, 0x80000
  s_mov_b32 s27, 0x7060501
  s_bfe_u32 s31, s88, 0x80008
  s_mov_b32 s28, 0x7060502
  s_bfe_u32 s32, s88, 0x80010
  s_mov_b32 s29, 0x7060503
  s_bfe_u32 s33, s88, 0x80018
  s_getreg_b32 s85, hwreg(HW_REG_XCC_ID)
  s_and_b32 s85, s85, 15
  s_lshl4_add_u32 s83, s52, s85
  s_lshl_b32 s83, s83, 8
  s_lshl_b32 s86, s4, 9
  s_add_u32 s86, s86, 98304
  s_lshl_b32 s84, s5, 4
  s_add_u32 s84, s84, s86
  v_and_b32 v45, 31, v0
  v_lshlrev_b32 v45, 4, v45
  v_mov_b32 v44, s83
  s_mov_b32 s81, 2
  s_mov_b64 exec, 1
  buffer_store_dword v44, off, s[16:19], s84
  s_mov_b64 exec, -1
  s_sub_u32 s53, s5, 9
  s_cmp_lt_u32 s53, 18
  s_cselect_b32 s59, 10, 25
  v_mov_b32 v4, 0
L_lw_145:
  ds_read_b32 v5, v4 offset:36
  s_waitcnt lgkmcnt(0)
  v_readfirstlane_b32 s53, v5
  s_nop 0
  s_cmp_ge_u32 s53, 11
  s_cbranch_scc1 L_lwd_146
  s_add_u32 s80, s80, 1
  s_cmp_gt_u32 s80, 4000000
  s_cbranch_scc1 L_exit
  s_sleep 4
  s_branch L_lw_145
L_lwd_146:
  buffer_load_dword v46, v45, s[16:19], s86 offen sc1
  s_waitcnt vmcnt(0)
  v_subrev_u32 v46, s83, v46
  v_cmp_gt_u32 vcc, 0x100, v46
  s_nop 0
  s_cmp_eq_u32 vcc_lo, -1
  s_cselect_b32 s81, 1, 2
  v_mov_b32 v47, s81
  ds_write_b32 v2, v47 offset:56
  v_mov_b32 v4, 0
L_lw_147:
  ds_read_b32 v5, v4 offset:36
  s_waitcnt lgkmcnt(0)
  v_readfirstlane_b32 s53, v5
  s_nop 0
  s_cmp_ge_u32 s53, 22
  s_cbranch_scc1 L_lwd_148
  s_add_u32 s80, s80, 1
  s_cmp_gt_u32 s80, 4000000
  s_cbranch_scc1 L_exit
  s_sleep 4
  s_branch L_lw_147
L_lwd_148:
  buffer_load_dword v46, v45, s[16:19], s86 offen sc1
  s_or_b32 s53, s83, 22
  v_mov_b32 v44, s53
  s_mov_b64 exec, 1
  buffer_store_dword v44, off, s[16:19], s84
  s_mov_b64 exec, -1
  s_waitcnt vmcnt(1)
  v_subrev_u32 v46, s83, v46
  v_cmp_gt_u32 vcc, 0x100, v46
  s_nop 0
  s_cmp_eq_u32 vcc_lo, -1
  s_cselect_b32 s81, 1, 2
  v_mov_b32 v47, s81
  ds_write_b32 v2, v47 offset:56
  v_subrev_u32 v46, 22, v46
  v_cmp_gt_u32 vcc, 0x90, v46
  s_nop 0
  s_bcnt1_i32_b32 s53, vcc_lo
  s_cmp_ge_i32 s53, 99
  s_cselect_b32 s54, 1, 0
  s_cmp_le_i32 s53, s59
  s_cselect_b32 s54, 2, s54
  s_cmp_eq_u32 s81, 1
  s_cselect_b32 s54, s54, 0
  v_mov_b32 v46, s54
  ds_write_b32 v2, v46 offset:64
  v_mov_b32 v4, 0
L_lw_149:
  ds_read_b32 v5, v4 offset:36
  s_waitcnt lgkmcnt(0)
  v_readfirstlane_b32 s53, v5
  s_nop 0
  s_cmp_ge_u32 s53, 29
  s_cbranch_scc1 L_lwd_150
  s_add_u32 s80, s80, 1
  s_cmp_gt_u32 s80, 4000000
  s_cbranch_scc1 L_exit
  s_sleep 4
  s_branch L_lw_149
L_lwd_150:
  buffer_load_dwordx4 v[16:19], v9, s[16:19], s60 offen offset:0 sc1
  buffer_load_dwordx4 v[20:23], v9, s[16:19], s61 offen offset:0 sc1
  buffer_load_dwordx4 v[24:27], v9, s[16:19], s62 offen offset:0 sc1
  buffer_load_dwordx4 v[28:31], v9, s[16:19], s60 offen offset:1024 sc1
  buffer_load_dwordx4 v[32:35], v9, s[16:19], s61 offen offset:1024 sc1
  buffer_load_dwordx4 v[36:39], v9, s[16:19], s62 offen offset:1024 sc1
  s_branch L_polle_153
L_poll_151:
  s_mov_b64 exec, s[64:65]
  buffer_load_dwordx4 v[16:19], v9, s[16:19], s60 offen offset:0 sc1
  s_mov_b64 exec, s[66:67]
  buffer_load_dwordx4 v[20:23], v9, s[16:19], s61 offen offset:0 sc1
  s_mov_b64 exec, s[68:69]
  buffer_load_dwordx4 v[24:27], v9, s[16:19], s62 offen offset:0 sc1
  s_mov_b64 exec, s[70:71]
  buffer_load_dwordx4 v[28:31], v9, s[16:19], s60 offen offset:1024 sc1
  s_mov_b64 exec, s[72:73]
  buffer_load_dwordx4 v[32:35], v9, s[16:19], s61 offen offset:1024 sc1
  s_mov_b64 exec, s[74:75]
  buffer_load_dwordx4 v[36:39], v9, s[16:19], s62 offen offset:1024 sc1
  s_mov_b64 exec, -1
  s_add_u32 s80, s80, 1
  s_cmp_gt_u32 s80, 4000000
  s_cbranch_scc1 L_exit
L_polle_153:
  s_waitcnt vmcnt(5)
  v_xor_b32 v4, s52, v17
  v_xor_b32 v5, s52, v19
  v_or_b32 v4, v4, v5
  v_cmp_ne_u32 s[64:65], 0, v4
  s_waitcnt vmcnt(4)
  v_xor_b32 v4, s52, v21
  v_xor_b32 v5, s52, v23
  v_or_b32 v4, v4, v5
  v_cmp_ne_u32 s[66:67], 0, v4
  s_waitcnt vmcnt(3)
  v_xor_b32 v4, s52, v25
  v_xor_b32 v5, s52, v27
  v_or_b32 v4, v4, v5
  v_cmp_ne_u32 s[68:69], 0, v4
  s_waitcnt vmcnt(2)
  v_xor_b32 v4, s52, v29
  v_xor_b32 v5, s52, v31
  v_or_b32 v4, v4, v5
  v_cmp_ne_u32 s[70:71], 0, v4
  s_waitcnt vmcnt(1)
  v_xor_b32 v4, s52, v33
  v_xor_b32 v5, s52, v35
  v_or_b32 v4, v4, v5
  v_cmp_ne_u32 s[72:73], 0, v4
  s_waitcnt vmcnt(0)
  v_xor_b32 v4, s52, v37
  v_xor_b32 v5, s52, v39
  v_or_b32 v4, v4, v5
  v_cmp_ne_u32 s[74:75], 0, v4
  s_or_b64 s[54:55], s[64:65], s[66:67]
  s_or_b64 s[54:55], s[54:55], s[68:69]
  s_or_b64 s[54:55], s[54:55], s[70:71]
  s_or_b64 s[54:55], s[54:55], s[72:73]
  s_or_b64 s[54:55], s[54:55], s[74:75]
  s_cbranch_scc0 L_polld_152
  s_sleep 4
  s_branch L_poll_151
L_polld_152:
  v_add_f32 v16, v16, v20
  v_add_f32 v16, v16, v24
  v_add_f32 v18, v18, v22
  v_add_f32 v18, v18, v26
  v_add_f32 v28, v28, v32
  v_add_f32 v28, v28, v36
  v_add_f32 v30, v30, v34
  v_add_f32 v30, v30, v38
  v_cvt_pk_bf16_f32 v16, v16, v18
  v_cvt_pk_bf16_f32 v28, v28, v30
  ds_write_b32 v1, v16 offset:256
  ds_write_b32 v1, v28 offset:512
  v_mov_b32 v4, 0
  v_mov_b32 v5, 1
  s_mov_b64 exec, 1
  ds_add_u32 v4, v5 offset:8
  s_mov_b64 exec, -1
  s_and_b32 s53, s6, 7
  s_cmp_ge_u32 s53, 6
  s_cbranch_scc0 L_nt1
  v_lshlrev_b32 v12, 7, v0
  s_mov_b64 exec, 0xff
  buffer_load_dword v61, v12, s[16:19], s82 offen nt
  buffer_load_dword v62, v12, s[16:19], s82 offen sc1
  s_mov_b64 exec, -1
L_nt1:
  s_lshl_b32 s53, s6, 6
  s_add_u32 s53, s53, 65536
  s_mov_b64 exec, 1
  buffer_load_dword v61, v2, s[16:19], s53 offen nt
  buffer_load_dword v62, v2, s[16:19], s53 offen sc1
  s_mov_b64 exec, -1
  s_cmp_lt_u32 s5, 9
  s_cbranch_scc0 L_nx1
  s_mul_i32 s53, s4, 5120
  s_lshl_b32 s54, s5, 9
  s_add_u32 s53, s53, s54
  s_add_u32 s53, s53, 1130496
  v_lshlrev_b32 v12, 7, v0
  s_mov_b64 exec, 0xf
  buffer_load_dword v61, v12, s[16:19], s53 offen nt
  buffer_load_dword v62, v12, s[16:19], s53 offen sc1
  s_mov_b64 exec, -1
L_nx1:
  s_cmp_lt_u32 s5, 25
  s_cbranch_scc1 L_nxt
  s_sub_u32 s53, s5, 9
  s_cmp_lt_u32 s53, 18
  s_cbranch_scc0 L_nxt
  s_mul_i32 s54, s4, 18
  s_add_u32 s53, s53, s54
  s_lshl_b32 s53, s53, 11
  s_add_u32 s53, s53, 1441792
  v_lshlrev_b32 v12, 7, v0
  s_mov_b64 exec, 0xffff
  buffer_load_dword v61, v12, s[16:19], s53 offen nt
  buffer_load_dword v62, v12, s[16:19], s53 offen sc1
  s_mov_b64 exec, -1
L_nxt:
  v_and_b32 v6, 15, v0
  v_lshlrev_b32 v6, 3, v6
  v_bfe_u32 v7, v0, 1, 3
  v_lshlrev_b32 v7, 6, v7
  v_and_b32 v8, 1, v0
  v_lshl_add_u32 v7, v8, 4, v7
  s_lshl_b32 s60, s6, 6
  s_add_u32 s60, s60, 65536
  s_and_b32 s61, s60, 0xfffffe00
  v_mov_b32 v4, 0
L_lw_154:
  ds_read_b32 v5, v4 offset:36
  s_waitcnt lgkmcnt(0)
  v_readfirstlane_b32 s53, v5
  s_nop 0
  s_cmp_ge_u32 s53, 34
  s_cbranch_scc1 L_lwd_155
  s_add_u32 s80, s80, 1
  s_cmp_gt_u32 s80, 4000000
  s_cbranch_scc1 L_exit
  s_sleep 4
  s_branch L_lw_154
L_lwd_155:
  buffer_load_dword v46, v45, s[16:19], s86 offen sc1
  s_or_b32 s53, s83, 34
  v_mov_b32 v44, s53
  s_mov_b64 exec, 1
  buffer_store_dword v44, off, s[16:19], s84
  s_mov_b64 exec, -1
  s_waitcnt vmcnt(1)
  v_subrev_u32 v46, s83, v46
  v_subrev_u32 v46, 34, v46
  v_cmp_gt_u32 vcc, 0x90, v46
  s_nop 0
  s_bcnt1_i32_b32 s53, vcc_lo
  s_cmp_ge_i32 s53, 99
  s_cselect_b32 s54, 1, 0
  s_cmp_le_i32 s53, s59
  s_cselect_b32 s54, 2, s54
  s_cmp_eq_u32 s81, 1
  s_cselect_b32 s54, s54, 0
  v_mov_b32 v46, s54
  ds_write_b32 v2, v46 offset:64
  v_mov_b32 v4, 0
L_lw_156:
  ds_read_b32 v5, v4 offset:12
  s_waitcnt lgkmcnt(0)
  v_readfirstlane_b32 s53, v5
  s_nop 0
  s_cmp_eq_u32 s53, 8
  s_cbranch_scc1 L_lwd_157
  s_add_u32 s80, s80, 1
  s_cmp_gt_u32 s80, 4000000
  s_cbranch_scc1 L_exit
  s_sleep 2
  s_branch L_lw_156
L_lwd_157:
  ds_read_b64 v[16:17], v6 offset:128
  s_waitcnt lgkmcnt(0)
  v_mov_b32 v18, v16
  s_nop 1
  v_max_f32_dpp v18, v18, v18 row_ror:2 row_mask:0xf bank_mask:0xf
  s_nop 1
  v_max_f32_dpp v18, v18, v18 row_ror:4 row_mask:0xf bank_mask:0xf
  s_nop 1
  v_max_f32_dpp v18, v18, v18 row_ror:8 row_mask:0xf bank_mask:0xf
  v_sub_f32 v16, v16, v18
  v_mul_f32 v16, 0x3fb8aa3b, v16
  v_exp_f32 v16, v16
  s_nop 0
  v_mul_f32 v17, v17, v16
  v_mov_b32 v16, v18
  s_nop 0
  v_add_f32_dpp v17, v17, v17 row_ror:2 row_mask:0xf bank_mask:0xf
  s_nop 1
  v_add_f32_dpp v17, v17, v17 row_ror:4 row_mask:0xf bank_mask:0xf
  s_nop 1
  v_add_f32_dpp v17, v17, v17 row_ror:8 row_mask:0xf bank_mask:0xf
  v_mov_b32 v18, v17
  v_mov_b32 v17, s52
  v_mov_b32 v19, s52
  s_mov_b64 exec, 0xf
  s_cmp_eq_u32 s81, 1
  s_cbranch_scc0 L_ls_158
  buffer_store_dwordx4 v[16:19], v9, s[16:19], s60 offen
  s_branch L_lsd_159
L_ls_158:
  buffer_store_dwordx4 v[16:19], v9, s[16:19], s60 offen sc1
L_lsd_159:
  s_mov_b64 exec, -1
  v_mov_b32 v4, 0
L_lw_160:
  ds_read_b32 v5, v4 offset:36
  s_waitcnt lgkmcnt(0)
  v_readfirstlane_b32 s53, v5
  s_nop 0
  s_cmp_ge_u32 s53, 46
  s_cbranch_scc1 L_lwd_161
  s_add_u32 s80, s80, 1
  s_cmp_gt_u32 s80, 4000000
  s_cbranch_scc1 L_exit
  s_sleep 4
  s_branch L_lw_160
L_lwd_161:
  buffer_load_dword v46, v45, s[16:19], s86 offen sc1
  s_or_b32 s53, s83, 46
  v_mov_b32 v44, s53
  s_mov_b64 exec, 1
  buffer_store_dword v44, off, s[16:19], s84
  s_mov_b64 exec, -1
  s_waitcnt vmcnt(1)
  v_subrev_u32 v46, s83, v46
  v_subrev_u32 v46, 46, v46
  v_cmp_gt_u32 vcc, 0x90, v46
  s_nop 0
  s_bcnt1_i32_b32 s53, vcc_lo
  s_cmp_ge_i32 s53, 99
  s_cselect_b32 s54, 1, 0
  s_cmp_le_i32 s53, s59
  s_cselect_b32 s54, 2, s54
  s_cmp_eq_u32 s81, 1
  s_cselect_b32 s54, s54, 0
  v_mov_b32 v46, s54
  ds_write_b32 v2, v46 offset:64
  v_mov_b32 v4, 0
L_lw_162:
  ds_read_b32 v5, v4 offset:36
  s_waitcnt lgkmcnt(0)
  v_readfirstlane_b32 s53, v5
  s_nop 0
  s_cmp_ge_u32 s53, 51
  s_cbranch_scc1 L_lwd_163
  s_add_u32 s80, s80, 1
  s_cmp_gt_u32 s80, 4000000
  s_cbranch_scc1 L_exit
  s_sleep 4
  s_branch L_lw_162
L_lwd_163:
  buffer_load_dword v46, v45, s[16:19], s86 offen sc1
  s_or_b32 s53, s83, 51
  v_mov_b32 v44, s53
  s_mov_b64 exec, 1
  buffer_store_dword v44, off, s[16:19], s84
  s_mov_b64 exec, -1
  s_waitcnt vmcnt(1)
  v_subrev_u32 v46, s83, v46
  v_subrev_u32 v46, 51, v46
  v_cmp_gt_u32 vcc, 0x90, v46
  s_nop 0
  s_bcnt1_i32_b32 s53, vcc_lo
  s_cmp_ge_i32 s53, 99
  s_cselect_b32 s54, 1, 0
  s_cmp_le_i32 s53, s59
  s_cselect_b32 s54, 2, s54
  s_cmp_eq_u32 s81, 1
  s_cselect_b32 s54, s54, 0
  v_mov_b32 v46, s54
  ds_write_b32 v2, v46 offset:64
  v_mov_b32 v4, 0
L_lw_164:
  ds_read_b32 v5, v4 offset:36
  s_waitcnt lgkmcnt(0)
  v_readfirstlane_b32 s53, v5
  s_nop 0
  s_cmp_ge_u32 s53, 54
  s_cbranch_scc1 L_lwd_165
  s_add_u32 s80, s80, 1
  s_cmp_gt_u32 s80, 4000000
  s_cbranch_scc1 L_exit
  s_sleep 4
  s_branch L_lw_164
L_lwd_165:
  buffer_load_dwordx4 v[20:23], v7, s[16:19], s61 offen sc1
  s_branch L_polle_168
L_poll_166:
  s_mov_b64 exec, s[64:65]
  buffer_load_dwordx4 v[20:23], v7, s[16:19], s61 offen sc1
  s_mov_b64 exec, -1
  s_add_u32 s80, s80, 1
  s_cmp_gt_u32 s80, 4000000
  s_cbranch_scc1 L_exit
L_polle_168:
  s_waitcnt vmcnt(0)
  v_xor_b32 v4, s52, v21
  v_xor_b32 v5, s52, v23
  v_or_b32 v4, v4, v5
  v_cmp_ne_u32 s[64:65], 0, v4
  s_nop 0
  s_cmp_lg_u64 s[64:65], 0
  s_cbranch_scc0 L_polld_167
  s_sleep 4
  s_branch L_poll_166
L_polld_167:
  v_mov_b32 v24, v20
  s_nop 1
  v_max_f32_dpp v24, v24, v24 row_ror:2 row_mask:0xf bank_mask:0xf
  s_nop 1
  v_max_f32_dpp v24, v24, v24 row_ror:4 row_mask:0xf bank_mask:0xf
  s_nop 1
  v_max_f32_dpp v24, v24, v24 row_ror:8 row_mask:0xf bank_mask:0xf
  v_sub_f32 v20, v20, v24
  v_mul_f32 v20, 0x3fb8aa3b, v20
  v_exp_f32 v20, v20
  s_nop 0
  v_mul_f32 v22, v22, v20
  v_mov_b32 v20, v24
  s_nop 0
  v_add_f32_dpp v22, v22, v22 row_ror:2 row_mask:0xf bank_mask:0xf
  s_nop 1
  v_add_f32_dpp v22, v22, v22 row_ror:4 row_mask:0xf bank_mask:0xf
  s_nop 1
  v_add_f32_dpp v22, v22, v22 row_ror:8 row_mask:0xf bank_mask:0xf
  v_rcp_f32 v21, v22
  s_mov_b64 exec, 3
  ds_write_b64 v6, v[20:21] offset:96
  s_mov_b64 exec, -1
  v_mov_b32 v24, 0
  v_mov_b32 v25, 0
  v_mov_b32 v26, 0
  v_mov_b32 v27, 0
  ds_write_b128 v9, v[24:27] offset:8192
  v_mov_b32 v4, 0
  v_mov_b32 v5, 1
  s_mov_b64 exec, 1
  ds_add_u32 v4, v5 offset:16
  s_mov_b64 exec, -1
  v_mov_b32 v4, 0
L_lw_169:
  ds_read_b32 v5, v4 offset:36
  s_waitcnt lgkmcnt(0)
  v_readfirstlane_b32 s53, v5
  s_nop 0
  s_cmp_ge_u32 s53, 58
  s_cbranch_scc1 L_lwd_170
  s_add_u32 s80, s80, 1
  s_cmp_gt_u32 s80, 4000000
  s_cbranch_scc1 L_exit
  s_sleep 4
  s_branch L_lw_169
L_lwd_170:
  buffer_load_dword v46, v45, s[16:19], s86 offen sc1
  s_or_b32 s53, s83, 58
  v_mov_b32 v44, s53
  s_mov_b64 exec, 1
  buffer_store_dword v44, off, s[16:19], s84
  s_mov_b64 exec, -1
  s_waitcnt vmcnt(1)
  v_subrev_u32 v46, s83, v46
  v_subrev_u32 v46, 58, v46
  v_cmp_gt_u32 vcc, 0x90, v46
  s_nop 0
  s_bcnt1_i32_b32 s53, vcc_lo
  s_cmp_ge_i32 s53, 99
  s_cselect_b32 s54, 1, 0
  s_cmp_le_i32 s53, s59
  s_cselect_b32 s54, 2, s54
  s_cmp_eq_u32 s81, 1
  s_cselect_b32 s54, s54, 0
  v_mov_b32 v46, s54
  ds_write_b32 v2, v46 offset:64
  v_mov_b32 v4, 0
L_lw_171:
  ds_read_b32 v5, v4 offset:20
  s_waitcnt lgkmcnt(0)
  v_readfirstlane_b32 s53, v5
  s_nop 0
  s_cmp_ge_u32 s53, 6
  s_cbranch_scc1 L_lwd_172
  s_add_u32 s80, s80, 1
  s_cmp_gt_u32 s80, 4000000
  s_cbranch_scc1 L_exit
  s_branch L_lw_171
L_lwd_172:
L_ow:
  ds_read_b32 v5, v2 offset:20
  ds_read_b128 v[16:19], v9 offset:8192
  ds_read_b128 v[20:23], v9 offset:9216
  ds_read_b128 v[24:27], v9 offset:10240
  ds_read_b128 v[28:31], v9 offset:11264
  ds_read_b128 v[32:35], v9 offset:12288
  ds_read_b128 v[36:39], v9 offset:13312
  ds_read_b128 v[40:43], v9 offset:14336
  ds_read_b128 v[44:47], v9 offset:15360
  s_add_u32 s80, s80, 1
  s_cmp_gt_u32 s80, 4000000
  s_cbranch_scc1 L_exit
  s_waitcnt lgkmcnt(8)
  v_readfirstlane_b32 s53, v5
  s_nop 0
  s_cmp_eq_u32 s53, 8
  s_cbranch_scc0 L_ow
  s_waitcnt lgkmcnt(6)
  v_pk_add_f32 v[16:17], v[16:17], v[20:21]
  v_pk_add_f32 v[18:19], v[18:19], v[22:23]
  s_waitcnt lgkmcnt(4)
  v_pk_add_f32 v[24:25], v[24:25], v[28:29]
  v_pk_add_f32 v[26:27], v[26:27], v[30:31]
  v_pk_add_f32 v[16:17], v[16:17], v[24:25]
  v_pk_add_f32 v[18:19], v[18:19], v[26:27]
  s_waitcnt lgkmcnt(2)
  v_pk_add_f32 v[32:33], v[32:33], v[36:37]
  v_pk_add_f32 v[34:35], v[34:35], v[38:39]
  s_waitcnt lgkmcnt(0)
  v_pk_add_f32 v[40:41], v[40:41], v[44:45]
  v_pk_add_f32 v[42:43], v[42:43], v[46:47]
  v_pk_add_f32 v[32:33], v[32:33], v[40:41]
  v_pk_add_f32 v[34:35], v[34:35], v[42:43]
  v_pk_add_f32 v[16:17], v[16:17], v[32:33]
  v_pk_add_f32 v[18:19], v[18:19], v[34:35]
  v_perm_b32 v16, v16, v11, s26
  v_perm_b32 v17, v17, v11, s27
  v_perm_b32 v18, v18, v11, s28
  v_perm_b32 v19, v19, v11, s29
  s_cmp_eq_u32 s81, 1
  s_cbranch_scc0 L_ls_173
  buffer_store_dwordx4 v[16:19], v9, s[16:19], s82 offen
  s_branch L_lsd_174
L_ls_173:
  buffer_store_dwordx4 v[16:19], v9, s[16:19], s82 offen sc1
L_lsd_174:
  v_mov_b32 v4, 0
  v_mov_b32 v5, 1
  s_mov_b64 exec, 1
  ds_add_u32 v4, v5 offset:32
  s_mov_b64 exec, -1
  s_cmp_lt_u32 s5, 9
  s_cbranch_scc0 L_exit
  s_barrier
L_exit:
L_end:
  s_endpgm
.section .rodata,"a"
.p2align 6
.amdhsa_kernel adaLN_cond__gqa_block_cached__glu_gated_swiglu__decode_kernel
  .amdhsa_next_free_vgpr 168
  .amdhsa_next_free_sgpr 102
  .amdhsa_accum_offset 168
  .amdhsa_group_segment_fixed_size 0
  .amdhsa_kernarg_size 112
  .amdhsa_user_sgpr_count 2
  .amdhsa_user_sgpr_kernarg_segment_ptr 1
  .amdhsa_system_sgpr_workgroup_id_x 1
  .amdhsa_float_denorm_mode_32 3
.end_amdhsa_kernel
```
